```python
import torch

def _softmax(x, axis=-1):
    return torch.softmax(x, dim=axis)
def _gelu(x):
    return torch.nn.functional.gelu(x, approximate="tanh")
def _silu(x):
    return torch.nn.functional.silu(x)
def _sigmoid(x):
    return torch.sigmoid(x)
def _layernorm(x, axis=-1, eps=1e-5):
    m = x.mean(dim=axis, keepdim=True)
    v = x.var(dim=axis, keepdim=True, unbiased=False)
    return (x - m) / torch.sqrt(v + eps)
def _scatter_add(tgt, idx, src, axis=0):
    return tgt.clone().index_add_(axis, idx, src)
def _segment_sum(src, seg, n):
    out = torch.zeros((n,) + src.shape[1:], dtype=src.dtype)
    return out.index_add_(0, seg, src)
def _pad(x, pw):
    flat = tuple(v for pair in reversed(pw) for v in pair)
    return torch.nn.functional.pad(x, flat)

kernel_name = 'standalone__kv_cache_quant_int4_int2_kv_with_per_channel_or_per_token_scales__prompt'

def setup_inputs():

    _w = (lambda a: (lambda t: t.to(torch.bfloat16) if t.is_floating_point() else t)(torch.as_tensor(a)))
    B = 1
    Sq = 2048
    Skv = 2048
    Hq = 32
    Hkv = 8
    Dh = 128
    bits = 8
    G = 128
    if G <= 0 or G >= Skv:
        G = max(1, Skv // 2)
    Skv = (Skv // G) * G
    ngk = Skv // G
    qmax = (1 << bits) - 1
    return {
        "q": _w((lambda *s: torch.randn(*s, dtype=torch.bfloat16) * 0.2)(B, Hq, Sq, Dh)),
        "qk": _w(torch.randint(0, qmax + 1, (B, Hkv, Skv, Dh)).to(torch.int32)),
        "qv": _w(torch.randint(0, qmax + 1, (B, Hkv, Skv, Dh)).to(torch.int32)),
        "k_scales": _w(torch.abs((lambda *s: torch.randn(*s, dtype=torch.bfloat16) * 0.2)(B, Hkv, ngk, Dh)) * 0.05 + 0.02),
        "k_zeros": _w((lambda *s: torch.randn(*s, dtype=torch.bfloat16) * 0.2)(B, Hkv, ngk, Dh) + float(qmax) / 2.0),
        "v_scales": _w(torch.abs((lambda *s: torch.randn(*s, dtype=torch.bfloat16) * 0.05)(B, Hkv, Skv, 1)) * 0.05 + 0.02),
        "v_zeros": _w((lambda *s: torch.randn(*s, dtype=torch.bfloat16) * 0.05)(B, Hkv, Skv, 1) + float(qmax) / 2.0),
    }

def reference(q, qk, qv, k_scales, k_zeros, v_scales, v_zeros):
    B, Hq, Sq, Dh = q.shape
    Hkv, Skv = qk.shape[1], qk.shape[2]
    ngk = k_scales.shape[2]
    G = Skv // ngk
    ks = (lambda x, n, axis: torch.repeat_interleave(x, n, dim=axis))(k_scales, G, axis=2)
    kz = (lambda x, n, axis: torch.repeat_interleave(x, n, dim=axis))(k_zeros, G, axis=2)
    k = ((lambda x, dt: x.to(dt))(qk, q.dtype) - kz) * ks
    v = ((lambda x, dt: x.to(dt))(qv, q.dtype) - v_zeros) * v_scales
    rep = Hq // Hkv
    if rep > 1:
        k = (lambda x, n, axis: torch.repeat_interleave(x, n, dim=axis))(k, rep, axis=1)
        v = (lambda x, n, axis: torch.repeat_interleave(x, n, dim=axis))(v, rep, axis=1)
    scale = float(Dh) ** -0.5
    logits = torch.einsum("bhqd,bhkd->bhqk", q, k) * scale
    p = _softmax(logits, axis=-1)
    o = torch.einsum("bhqk,bhkd->bhqd", p, v)
    return o
```

```asm
; @launch grid=(256,1,1) block=(256,1,1) lds=163840
.amdgcn_target "amdgcn-amd-amdhsa--gfx950"
.text
.globl standalone__kv_cache_quant_int4_int2_kv_with_per_channel_or_per_token_scales__prompt_kernel
.p2align 8
.type standalone__kv_cache_quant_int4_int2_kv_with_per_channel_or_per_token_scales__prompt_kernel,@function
standalone__kv_cache_quant_int4_int2_kv_with_per_channel_or_per_token_scales__prompt_kernel:
    s_cmp_ge_u32 s2, 256
    s_cbranch_scc1 L_end
    s_load_dwordx16 s[80:95], s[0:1], 0
    s_load_dwordx4 s[96:99], s[0:1], 64
    s_memrealtime s[62:63]
    v_lshrrev_b32 v5, 6, v0
    v_and_b32 v0, 63, v0
    v_readfirstlane_b32 s20, v5
    v_lshlrev_b32 v1, 4, v0
    s_and_b32 s28, s2, 7
    s_lshr_b32 s29, s2, 3
    s_lshl_b32 s30, s28, 20
    s_lshr_b32 s41, s20, 1
    s_mov_b32 s70, 0x3e0293ee
    s_mov_b32 s71, s70
    s_getreg_b32 s21, hwreg(HW_REG_XCC_ID, 0, 4)
    s_mov_b32 s43, 0
    s_mov_b32 s24, 0
    s_mov_b32 s42, 0
    s_lshl_b32 s31, s28, 5
    s_add_u32 s31, s31, s29
    s_lshl_b32 s31, s31, 16
    s_lshl_b32 s3, s20, 14
    s_add_u32 s31, s31, s3
    s_add_u32 s32, s31, 4096
    s_add_u32 s33, s31, 8192
    s_add_u32 s34, s31, 12288
    v_and_b32 v6, 15, v0
    v_lshrrev_b32 v7, 4, v0
    v_lshlrev_b32 v4, 8, v6
    v_lshl_add_u32 v4, v7, 4, v4
    s_waitcnt lgkmcnt(0)
    s_add_u32 s12, s98, s30
    s_addc_u32 s13, s99, 0
    s_mov_b32 s14, 0x100000
    s_mov_b32 s15, 0x20000
    s_mov_b32 s16, s80
    s_mov_b32 s17, s81
    s_mov_b32 s18, 0x1000000
    s_mov_b32 s19, 0x20000
    s_mov_b32 s26, s98
    s_mov_b32 s27, s99
    s_add_u32 s4, s98, 0x800000
    s_addc_u32 s5, s99, 0
    s_mov_b32 s6, 0xc000
    s_mov_b32 s7, 0x20000
    s_bitcmp1_b32 s20, 0
    s_cbranch_scc1 L_oddw
    s_call_b64 s[66:67], L_early
    v_mov_b32 v12, 0x20000
    v_mov_b32 v14, -1.0
    v_mov_b32 v15, 0x5d800000
    ds_write_b64 v12, v[14:15]
    s_waitcnt lgkmcnt(0)
    s_barrier
    s_branch L_odd
L_early:
    s_lshr_b32 s22, s29, 2
    s_and_b32 s23, s29, 3
    s_call_b64 s[64:65], L_usetup
    s_call_b64 s[64:65], L_uload
    s_branch L_early_2
L_usetup:
    s_lshl_b32 s39, s22, 14
    s_lshl_b32 s3, s23, 11
    s_add_u32 s36, s39, s3
    s_add_u32 s36, s36, s30
    s_add_u32 s37, s36, 8192
    s_lshl_b32 s38, s28, 12
    s_mov_b32 s10, 0x800000
    s_mov_b32 s11, 0x20000
    s_mov_b32 s74, 0x8000
    s_mov_b32 s75, 0x20000
    s_mov_b32 s78, 0x8000
    s_mov_b32 s79, 0x20000
    s_cmp_lg_u32 s41, 0
    s_cbranch_scc1 L_usetup_v
    s_mov_b32 s8, s82
    s_mov_b32 s9, s83
    s_mov_b32 s72, s86
    s_mov_b32 s73, s87
    s_mov_b32 s76, s88
    s_mov_b32 s77, s89
    s_lshr_b32 s3, s22, 2
    s_lshl_b32 s3, s3, 8
    s_add_u32 s38, s38, s3
    s_lshl_b32 s3, s23, 6
    s_add_u32 s39, s39, s3
    s_add_u32 s40, s39, 4096
    v_and_b32 v12, 3, v0
    v_bfe_u32 v13, v0, 2, 2
    v_lshrrev_b32 v14, 4, v0
    v_lshlrev_b32 v10, 9, v12
    v_lshl_add_u32 v10, v14, 7, v10
    v_lshl_add_u32 v10, v13, 5, v10
    v_lshlrev_b32 v5, 10, v14
    v_lshl_add_u32 v5, v13, 8, v5
    v_lshl_add_u32 v5, v12, 4, v5
    s_setpc_b64 s[64:65]
L_usetup_v:
    s_mov_b32 s8, s84
    s_mov_b32 s9, s85
    s_mov_b32 s72, s90
    s_mov_b32 s73, s91
    s_mov_b32 s76, s92
    s_mov_b32 s77, s93
    s_lshl_b32 s3, s22, 6
    s_add_u32 s38, s38, s3
    s_lshl_b32 s3, s23, 3
    s_add_u32 s38, s38, s3
    s_lshl_b32 s3, s23, 8
    s_add_u32 s39, s39, s3
    s_add_u32 s39, s39, 8192
    v_and_b32 v12, 31, v0
    v_lshrrev_b32 v13, 5, v0
    v_lshlrev_b32 v10, 13, v13
    v_lshl_add_u32 v10, v12, 4, v10
    v_lshrrev_b32 v14, 1, v12
    v_lshlrev_b32 v5, 4, v14
    v_and_b32 v14, 1, v12
    v_lshl_add_u32 v5, v14, 12, v5
    v_lshl_add_u32 v5, v13, 11, v5
    s_setpc_b64 s[64:65]
L_uload:
    s_cmp_lg_u32 s41, 0
    s_cbranch_scc1 L_uload_v
    v_bfe_u32 v12, v10, 1, 8
    buffer_load_dwordx4 v[56:59], v12, s[72:75], s38 offen
    buffer_load_dwordx4 v[60:63], v12, s[76:79], s38 offen
    buffer_load_dwordx4 v[16:19], v10, s[8:11], s36 offen offset:0
    buffer_load_dwordx4 v[20:23], v10, s[8:11], s36 offen offset:16
    buffer_load_dwordx4 v[24:27], v10, s[8:11], s37 offen offset:0
    buffer_load_dwordx4 v[28:31], v10, s[8:11], s37 offen offset:16
    s_branch L_uload_e
L_uload_v:
    v_lshrrev_b32 v12, 8, v10
    v_and_b32 v12, 32, v12
    buffer_load_dwordx2 v[56:57], v12, s[72:75], s38 offen
    buffer_load_dwordx2 v[58:59], v12, s[76:79], s38 offen
    buffer_load_dwordx4 v[16:19], v10, s[8:11], s36 offen offset:0
    buffer_load_dwordx4 v[20:23], v10, s[8:11], s36 offen offset:512
    buffer_load_dwordx4 v[24:27], v10, s[8:11], s36 offen offset:1024
    buffer_load_dwordx4 v[28:31], v10, s[8:11], s36 offen offset:1536
L_uload_e:
    s_add_u32 s36, s36, 0x40000
    s_add_u32 s37, s37, 0x40000
    s_add_u32 s38, s38, 1024
    s_cmp_eq_u32 s24, 2
    s_cbranch_scc1 L_flag_n
    s_setpc_b64 s[64:65]
L_early_2:
    s_sub_u32 s3, s36, 0x20000
    s_sub_u32 s68, s37, 0x20000
    s_sub_u32 s69, s38, 512
    s_cmp_lg_u32 s41, 0
    s_cbranch_scc1 L_early_v
    buffer_load_dwordx4 v[64:67], v12, s[72:75], s69 offen
    buffer_load_dwordx4 v[68:71], v12, s[76:79], s69 offen
    buffer_load_dwordx4 v[32:35], v10, s[8:11], s3 offen offset:0
    buffer_load_dwordx4 v[36:39], v10, s[8:11], s3 offen offset:16
    buffer_load_dwordx4 v[40:43], v10, s[8:11], s68 offen offset:0
    buffer_load_dwordx4 v[44:47], v10, s[8:11], s68 offen offset:16
    s_branch L_early_w
L_early_v:
    buffer_load_dwordx2 v[64:65], v12, s[72:75], s69 offen
    buffer_load_dwordx2 v[66:67], v12, s[76:79], s69 offen
    buffer_load_dwordx4 v[32:35], v10, s[8:11], s3 offen offset:0
    buffer_load_dwordx4 v[36:39], v10, s[8:11], s3 offen offset:512
    buffer_load_dwordx4 v[40:43], v10, s[8:11], s3 offen offset:1024
    buffer_load_dwordx4 v[44:47], v10, s[8:11], s3 offen offset:1536
L_early_w:
    s_cmp_lg_u32 s42, 0
    s_cbranch_scc1 L_early_x
    s_barrier
L_early_x:
    s_waitcnt vmcnt(6)
    s_call_b64 s[64:65], L_uproc
    s_sub_u32 s39, s39, 0x20000
    s_sub_u32 s40, s40, 0x20000
    s_waitcnt vmcnt(2)
    v_pk_mov_b32 v[16:17], v[32:33], v[32:33] op_sel:[0,1]
    v_pk_mov_b32 v[18:19], v[34:35], v[34:35] op_sel:[0,1]
    v_pk_mov_b32 v[20:21], v[36:37], v[36:37] op_sel:[0,1]
    v_pk_mov_b32 v[22:23], v[38:39], v[38:39] op_sel:[0,1]
    v_pk_mov_b32 v[24:25], v[40:41], v[40:41] op_sel:[0,1]
    v_pk_mov_b32 v[26:27], v[42:43], v[42:43] op_sel:[0,1]
    v_pk_mov_b32 v[28:29], v[44:45], v[44:45] op_sel:[0,1]
    v_pk_mov_b32 v[30:31], v[46:47], v[46:47] op_sel:[0,1]
    v_pk_mov_b32 v[56:57], v[64:65], v[64:65] op_sel:[0,1]
    v_pk_mov_b32 v[58:59], v[66:67], v[66:67] op_sel:[0,1]
    v_pk_mov_b32 v[60:61], v[68:69], v[68:69] op_sel:[0,1]
    v_pk_mov_b32 v[62:63], v[70:71], v[70:71] op_sel:[0,1]
    s_call_b64 s[64:65], L_uproc
    s_sub_u32 s39, s39, 0x20000
    s_sub_u32 s40, s40, 0x20000
    s_setpc_b64 s[66:67]
L_uproc:
    v_cvt_f32_i32 v16, v16
    v_cvt_f32_i32 v17, v17
    v_cvt_f32_i32 v18, v18
    v_cvt_f32_i32 v19, v19
    v_cvt_f32_i32 v20, v20
    v_cvt_f32_i32 v21, v21
    v_cvt_f32_i32 v22, v22
    v_cvt_f32_i32 v23, v23
    v_cvt_f32_i32 v24, v24
    v_cvt_f32_i32 v25, v25
    v_cvt_f32_i32 v26, v26
    v_cvt_f32_i32 v27, v27
    v_cvt_f32_i32 v28, v28
    v_cvt_f32_i32 v29, v29
    v_cvt_f32_i32 v30, v30
    v_cvt_f32_i32 v31, v31
    s_cmp_lg_u32 s41, 0
    s_cbranch_scc1 L_uproc_v
    v_lshlrev_b32 v12, 16, v60
    v_and_b32 v13, 0xffff0000, v60
    v_lshlrev_b32 v14, 16, v56
    v_and_b32 v15, 0xffff0000, v56
    v_pk_add_f32 v[16:17], v[16:17], v[12:13] neg_lo:[0,1] neg_hi:[0,1]
    v_pk_add_f32 v[24:25], v[24:25], v[12:13] neg_lo:[0,1] neg_hi:[0,1]
    v_pk_mul_f32 v[14:15], v[14:15], s[70:71]
    v_pk_mul_f32 v[16:17], v[16:17], v[14:15]
    v_pk_mul_f32 v[24:25], v[24:25], v[14:15]
    v_cvt_pk_bf16_f32 v16, v16, v17
    v_cvt_pk_bf16_f32 v24, v24, v25
    v_lshlrev_b32 v12, 16, v61
    v_and_b32 v13, 0xffff0000, v61
    v_lshlrev_b32 v14, 16, v57
    v_and_b32 v15, 0xffff0000, v57
    v_pk_add_f32 v[18:19], v[18:19], v[12:13] neg_lo:[0,1] neg_hi:[0,1]
    v_pk_add_f32 v[26:27], v[26:27], v[12:13] neg_lo:[0,1] neg_hi:[0,1]
    v_pk_mul_f32 v[14:15], v[14:15], s[70:71]
    v_pk_mul_f32 v[18:19], v[18:19], v[14:15]
    v_pk_mul_f32 v[26:27], v[26:27], v[14:15]
    v_cvt_pk_bf16_f32 v17, v18, v19
    v_cvt_pk_bf16_f32 v25, v26, v27
    v_lshlrev_b32 v12, 16, v62
    v_and_b32 v13, 0xffff0000, v62
    v_lshlrev_b32 v14, 16, v58
    v_and_b32 v15, 0xffff0000, v58
    v_pk_add_f32 v[20:21], v[20:21], v[12:13] neg_lo:[0,1] neg_hi:[0,1]
    v_pk_add_f32 v[28:29], v[28:29], v[12:13] neg_lo:[0,1] neg_hi:[0,1]
    v_pk_mul_f32 v[14:15], v[14:15], s[70:71]
    v_pk_mul_f32 v[20:21], v[20:21], v[14:15]
    v_pk_mul_f32 v[28:29], v[28:29], v[14:15]
    v_cvt_pk_bf16_f32 v18, v20, v21
    v_cvt_pk_bf16_f32 v26, v28, v29
    v_lshlrev_b32 v12, 16, v63
    v_and_b32 v13, 0xffff0000, v63
    v_lshlrev_b32 v14, 16, v59
    v_and_b32 v15, 0xffff0000, v59
    v_pk_add_f32 v[22:23], v[22:23], v[12:13] neg_lo:[0,1] neg_hi:[0,1]
    v_pk_add_f32 v[30:31], v[30:31], v[12:13] neg_lo:[0,1] neg_hi:[0,1]
    v_pk_mul_f32 v[14:15], v[14:15], s[70:71]
    v_pk_mul_f32 v[22:23], v[22:23], v[14:15]
    v_pk_mul_f32 v[30:31], v[30:31], v[14:15]
    v_cvt_pk_bf16_f32 v19, v22, v23
    v_cvt_pk_bf16_f32 v27, v30, v31
    s_cmp_lg_u32 s42, 0
    s_cbranch_scc1 L_uproc_km
    buffer_store_dwordx4 v[16:19], v5, s[12:15], s39 offen
    buffer_store_dwordx4 v[24:27], v5, s[12:15], s40 offen
    s_branch L_uproc_e
L_uproc_km:
    buffer_store_dwordx4 v[16:19], v5, s[12:15], s39 offen sc1
    buffer_store_dwordx4 v[24:27], v5, s[12:15], s40 offen sc1
    s_branch L_uproc_e
L_uproc_vm:
    buffer_store_dwordx4 v[56:59], v5, s[12:15], s39 offen sc1
    buffer_store_dwordx4 v[60:63], v5, s[12:15], s39 offen offset:1024 sc1
    s_branch L_uproc_e
L_uproc_v:
    s_nop 0
    v_lshlrev_b32 v60, 16, v58
    v_and_b32 v61, 0xffff0000, v58
    v_lshlrev_b32 v12, 16, v56
    v_and_b32 v13, 0xffff0000, v56
    v_lshlrev_b32 v62, 16, v59
    v_and_b32 v63, 0xffff0000, v59
    v_lshlrev_b32 v14, 16, v57
    v_and_b32 v15, 0xffff0000, v57
    v_pk_add_f32 v[16:17], v[16:17], v[60:61] op_sel_hi:[1,0] neg_lo:[0,1] neg_hi:[0,1]
    v_pk_add_f32 v[18:19], v[18:19], v[60:61] op_sel_hi:[1,0] neg_lo:[0,1] neg_hi:[0,1]
    v_pk_add_f32 v[20:21], v[20:21], v[60:61] op_sel:[0,1] op_sel_hi:[1,1] neg_lo:[0,1] neg_hi:[0,1]
    v_pk_add_f32 v[22:23], v[22:23], v[60:61] op_sel:[0,1] op_sel_hi:[1,1] neg_lo:[0,1] neg_hi:[0,1]
    v_pk_add_f32 v[24:25], v[24:25], v[62:63] op_sel_hi:[1,0] neg_lo:[0,1] neg_hi:[0,1]
    v_pk_add_f32 v[26:27], v[26:27], v[62:63] op_sel_hi:[1,0] neg_lo:[0,1] neg_hi:[0,1]
    v_pk_add_f32 v[28:29], v[28:29], v[62:63] op_sel:[0,1] op_sel_hi:[1,1] neg_lo:[0,1] neg_hi:[0,1]
    v_pk_add_f32 v[30:31], v[30:31], v[62:63] op_sel:[0,1] op_sel_hi:[1,1] neg_lo:[0,1] neg_hi:[0,1]
    v_pk_mul_f32 v[16:17], v[16:17], v[12:13] op_sel_hi:[1,0]
    v_pk_mul_f32 v[18:19], v[18:19], v[12:13] op_sel_hi:[1,0]
    v_pk_mul_f32 v[20:21], v[20:21], v[12:13] op_sel:[0,1] op_sel_hi:[1,1]
    v_pk_mul_f32 v[22:23], v[22:23], v[12:13] op_sel:[0,1] op_sel_hi:[1,1]
    v_pk_mul_f32 v[24:25], v[24:25], v[14:15] op_sel_hi:[1,0]
    v_pk_mul_f32 v[26:27], v[26:27], v[14:15] op_sel_hi:[1,0]
    v_pk_mul_f32 v[28:29], v[28:29], v[14:15] op_sel:[0,1] op_sel_hi:[1,1]
    v_pk_mul_f32 v[30:31], v[30:31], v[14:15] op_sel:[0,1] op_sel_hi:[1,1]
    v_cvt_pk_bf16_f32 v56, v16, v20
    v_cvt_pk_bf16_f32 v57, v24, v28
    v_cvt_pk_bf16_f32 v60, v17, v21
    v_cvt_pk_bf16_f32 v61, v25, v29
    v_cvt_pk_bf16_f32 v58, v18, v22
    v_cvt_pk_bf16_f32 v59, v26, v30
    v_cvt_pk_bf16_f32 v62, v19, v23
    v_cvt_pk_bf16_f32 v63, v27, v31
    s_cmp_lg_u32 s42, 0
    v_permlane32_swap_b32 v56, v58
    v_permlane32_swap_b32 v57, v59
    v_permlane32_swap_b32 v60, v62
    v_permlane32_swap_b32 v61, v63
    s_cbranch_scc1 L_uproc_vm
    buffer_store_dwordx4 v[56:59], v5, s[12:15], s39 offen
    buffer_store_dwordx4 v[60:63], v5, s[12:15], s39 offen offset:1024
L_uproc_e:
    s_add_u32 s39, s39, 0x40000
    s_add_u32 s40, s40, 0x40000
    s_bitcmp1_b32 6, s24
    s_cbranch_scc1 L_uload
    s_setpc_b64 s[64:65]
L_flag_n:
    s_add_u32 s101, s101, 0x4000
L_flag:
    v_mov_b32 v12, s62
    v_mov_b32 v13, s63
    v_mov_b32 v14, 0
    s_mov_b64 exec, 1
    buffer_store_dwordx2 v[12:13], v14, s[4:7], s101 offen
    s_cmp_eq_u32 s42, 0
    s_cbranch_scc1 L_flag_e
    v_mov_b32 v15, 0x2000
    v_or_b32 v13, 0xf0000000, v13
    buffer_store_dwordx2 v[12:13], v15, s[4:7], s101 offen sc1
L_flag_e:
    s_mov_b64 exec, -1
    s_setpc_b64 s[64:65]
L_oddw:
    s_lshr_b32 s22, s29, 2
    s_add_u32 s22, s22, 24
    s_and_b32 s23, s29, 3
    s_call_b64 s[64:65], L_usetup
    s_barrier
    buffer_load_dwordx4 a[0:3], v4, s[16:19], s31 offen offset:0
    buffer_load_dwordx4 a[4:7], v4, s[16:19], s31 offen offset:64
    buffer_load_dwordx4 a[8:11], v4, s[16:19], s31 offen offset:128
    buffer_load_dwordx4 a[12:15], v4, s[16:19], s31 offen offset:192
    buffer_load_dwordx4 a[16:19], v4, s[16:19], s32 offen offset:0
    buffer_load_dwordx4 a[20:23], v4, s[16:19], s32 offen offset:64
    buffer_load_dwordx4 a[24:27], v4, s[16:19], s32 offen offset:128
    buffer_load_dwordx4 a[28:31], v4, s[16:19], s32 offen offset:192
    s_barrier
    s_branch L_odd2
L_odd:
    buffer_load_dwordx4 a[0:3], v4, s[16:19], s31 offen offset:0
    buffer_load_dwordx4 a[4:7], v4, s[16:19], s31 offen offset:64
    buffer_load_dwordx4 a[8:11], v4, s[16:19], s31 offen offset:128
    buffer_load_dwordx4 a[12:15], v4, s[16:19], s31 offen offset:192
    buffer_load_dwordx4 a[16:19], v4, s[16:19], s32 offen offset:0
    buffer_load_dwordx4 a[20:23], v4, s[16:19], s32 offen offset:64
    buffer_load_dwordx4 a[24:27], v4, s[16:19], s32 offen offset:128
    buffer_load_dwordx4 a[28:31], v4, s[16:19], s32 offen offset:192
L_odd2:
    s_lshl_b32 s3, s29, 2
    s_add_u32 s3, s3, s20
    s_xor_b32 s3, s3, 1
    s_cmp_ge_u32 s3, 32
    s_cbranch_scc1 L_nopf
    s_and_b32 s3, s3, 3
    s_cmp_lg_u32 s3, 0
    s_cbranch_scc1 L_nopf
    s_getpc_b64 s[68:69]
    s_lshl_b32 s3, s29, 10
    s_add_u32 s68, s68, s3
    s_addc_u32 s69, s69, 0
    v_mov_b32 v41, s69
    v_add_co_u32 v40, vcc, s68, v1
    s_nop 1
    v_addc_co_u32 v41, vcc, 0, v41, vcc
    global_load_dwordx4 v[44:47], v[40:41], off
L_nopf:
    s_mov_b32 s25, 2048
    s_cmp_eq_u32 s20, 3
    s_cselect_b32 s35, 0xc3f, 0x3f
    s_xor_b32 s3, s20, 2
    s_or_b32 s3, s3, s29
    s_cmp_eq_u32 s3, 0
    s_cselect_b32 s35, 0x800003f, s35
    s_lshl_b32 s100, s28, 10
    s_lshl_b32 s101, s29, 2
    s_add_u32 s101, s101, s20
    s_lshl_b32 s101, s101, 3
    s_add_u32 s101, s101, s100
    s_add_u32 s21, s21, 1
    s_lshl_b32 s21, s21, 28
    s_and_b32 s63, s63, 0x0fffffff
    s_or_b32 s63, s63, s21
    s_sub_u32 s60, s62, 2000
    s_subb_u32 s61, s63, 0
    s_waitcnt vmcnt(8)
    s_call_b64 s[64:65], L_flag
    v_mov_b32 v64, v56
    v_mov_b32 v65, v57
    v_mov_b32 v66, v58
    v_mov_b32 v67, v59
    v_mov_b32 v68, v60
    v_mov_b32 v69, v61
    v_mov_b32 v70, v62
    v_mov_b32 v71, v63
    buffer_load_dwordx4 v[56:59], v1, s[4:7], s100 offen sc1
    buffer_load_dwordx4 a[32:35], v4, s[16:19], s33 offen offset:0
    buffer_load_dwordx4 a[36:39], v4, s[16:19], s33 offen offset:64
    buffer_load_dwordx4 a[40:43], v4, s[16:19], s33 offen offset:128
    buffer_load_dwordx4 a[44:47], v4, s[16:19], s33 offen offset:192
    buffer_load_dwordx4 a[48:51], v4, s[16:19], s34 offen offset:0
    buffer_load_dwordx4 a[52:55], v4, s[16:19], s34 offen offset:64
    buffer_load_dwordx4 a[56:59], v4, s[16:19], s34 offen offset:128
    buffer_load_dwordx4 a[60:63], v4, s[16:19], s34 offen offset:192
    v_mov_b32 v15, 0x20000
    s_cmp_lg_u32 s20, 2
    s_cbranch_scc1 L_nosc
    v_mov_b32 v12, 0
    v_and_b32 v13, 0x7fff0000, v64
    v_lshlrev_b32 v14, 16, v64
    v_add_f32 v12, v12, v13
    v_add_f32 v12, v12, abs(v14)
    v_and_b32 v13, 0x7fff0000, v65
    v_lshlrev_b32 v14, 16, v65
    v_add_f32 v12, v12, v13
    v_add_f32 v12, v12, abs(v14)
    v_and_b32 v13, 0x7fff0000, v66
    v_lshlrev_b32 v14, 16, v66
    v_add_f32 v12, v12, v13
    v_add_f32 v12, v12, abs(v14)
    v_and_b32 v13, 0x7fff0000, v67
    v_lshlrev_b32 v14, 16, v67
    v_add_f32 v12, v12, v13
    v_add_f32 v12, v12, abs(v14)
    v_and_b32 v13, 0x7fff0000, v68
    v_lshlrev_b32 v14, 16, v68
    v_add_f32 v12, v12, v13
    v_add_f32 v12, v12, abs(v14)
    v_and_b32 v13, 0x7fff0000, v69
    v_lshlrev_b32 v14, 16, v69
    v_add_f32 v12, v12, v13
    v_add_f32 v12, v12, abs(v14)
    v_and_b32 v13, 0x7fff0000, v70
    v_lshlrev_b32 v14, 16, v70
    v_add_f32 v12, v12, v13
    v_add_f32 v12, v12, abs(v14)
    v_and_b32 v13, 0x7fff0000, v71
    v_lshlrev_b32 v14, 16, v71
    v_add_f32 v12, v12, v13
    v_add_f32 v12, v12, abs(v14)
    v_min_f32 v12, 0x5d800000, v12
    ds_min_f32 v15, v12 offset:4
    ds_read_b32 v12, v15 offset:4
    s_waitcnt lgkmcnt(0)
    ds_write_b32 v15, v12
L_nosc:
    s_mov_b32 s16, s94
    s_mov_b32 s17, s95
    s_mov_b32 s18, 0x1000000
    s_mov_b32 s19, 0x20000
    v_lshlrev_b32 v6, 2, v0
    v_add_u32 v6, 0x20100, v6
    v_and_b32 v8, 3, v0
    v_lshl_add_u32 v8, v8, 8, v6
    s_lshl_b32 s3, s20, 8
    v_add_u32 v6, s3, v6
    v_mov_b32 v7, 0
    ds_write_b32 v6, v7
    v_mov_b32 v3, v1
    v_mov_b32 v2, v1
L_sc:
    ds_read_b32 v12, v15
    s_waitcnt lgkmcnt(0)
    v_cmp_gt_f32 vcc, 0, v12
    s_cbranch_vccnz L_sc
    v_mul_f32 v12, 0x32000000, v12
    s_nop 0
    v_readfirstlane_b32 s99, v12
    v_mov_b32 v128, v12
    v_mov_b32 v129, v12
    v_mov_b32 v130, v12
    v_mov_b32 v131, v12
    v_mov_b32 v132, v12
    v_mov_b32 v133, v12
    v_mov_b32 v134, v12
    v_mov_b32 v135, v12
    v_mov_b32 v136, v12
    v_mov_b32 v137, v12
    v_mov_b32 v138, v12
    v_mov_b32 v139, v12
    v_mov_b32 v140, v12
    v_mov_b32 v141, v12
    v_mov_b32 v142, v12
    v_mov_b32 v143, v12
    v_mov_b32 v144, v12
    v_mov_b32 v145, v12
    v_mov_b32 v146, v12
    v_mov_b32 v147, v12
    v_mov_b32 v148, v12
    v_mov_b32 v149, v12
    v_mov_b32 v150, v12
    v_mov_b32 v151, v12
    v_mov_b32 v152, v12
    v_mov_b32 v153, v12
    v_mov_b32 v154, v12
    v_mov_b32 v155, v12
    v_mov_b32 v156, v12
    v_mov_b32 v157, v12
    v_mov_b32 v158, v12
    v_mov_b32 v159, v12
    v_mov_b32 v160, v12
    v_mov_b32 v161, v12
    v_mov_b32 v162, v12
    v_mov_b32 v163, v12
    v_mov_b32 v164, v12
    v_mov_b32 v165, v12
    v_mov_b32 v166, v12
    v_mov_b32 v167, v12
    v_mov_b32 v168, v12
    v_mov_b32 v169, v12
    v_mov_b32 v170, v12
    v_mov_b32 v171, v12
    v_mov_b32 v172, v12
    v_mov_b32 v173, v12
    v_mov_b32 v174, v12
    v_mov_b32 v175, v12
    v_mov_b32 v176, v12
    v_mov_b32 v177, v12
    v_mov_b32 v178, v12
    v_mov_b32 v179, v12
    v_mov_b32 v180, v12
    v_mov_b32 v181, v12
    v_mov_b32 v182, v12
    v_mov_b32 v183, v12
    v_mov_b32 v184, v12
    v_mov_b32 v185, v12
    v_mov_b32 v186, v12
    v_mov_b32 v187, v12
    v_mov_b32 v188, v12
    v_mov_b32 v189, v12
    v_mov_b32 v190, v12
    v_mov_b32 v191, v12
    v_mov_b32 v192, v12
    v_mov_b32 v193, v12
    v_mov_b32 v194, v12
    v_mov_b32 v195, v12
    v_mov_b32 v196, v12
    v_mov_b32 v197, v12
    v_mov_b32 v198, v12
    v_mov_b32 v199, v12
    v_mov_b32 v200, v12
    v_mov_b32 v201, v12
    v_mov_b32 v202, v12
    v_mov_b32 v203, v12
    v_mov_b32 v204, v12
    v_mov_b32 v205, v12
    v_mov_b32 v206, v12
    v_mov_b32 v207, v12
    v_mov_b32 v208, v12
    v_mov_b32 v209, v12
    v_mov_b32 v210, v12
    v_mov_b32 v211, v12
    v_mov_b32 v212, v12
    v_mov_b32 v213, v12
    v_mov_b32 v214, v12
    v_mov_b32 v215, v12
    v_mov_b32 v216, v12
    v_mov_b32 v217, v12
    v_mov_b32 v218, v12
    v_mov_b32 v219, v12
    v_mov_b32 v220, v12
    v_mov_b32 v221, v12
    v_mov_b32 v222, v12
    v_mov_b32 v223, v12
    v_mov_b32 v224, v12
    v_mov_b32 v225, v12
    v_mov_b32 v226, v12
    v_mov_b32 v227, v12
    v_mov_b32 v228, v12
    v_mov_b32 v229, v12
    v_mov_b32 v230, v12
    v_mov_b32 v231, v12
    v_mov_b32 v232, v12
    v_mov_b32 v233, v12
    v_mov_b32 v234, v12
    v_mov_b32 v235, v12
    v_mov_b32 v236, v12
    v_mov_b32 v237, v12
    v_mov_b32 v238, v12
    v_mov_b32 v239, v12
    v_mov_b32 v240, v12
    v_mov_b32 v241, v12
    v_mov_b32 v242, v12
    v_mov_b32 v243, v12
    v_mov_b32 v244, v12
    v_mov_b32 v245, v12
    v_mov_b32 v246, v12
    v_mov_b32 v247, v12
    v_mov_b32 v248, v12
    v_mov_b32 v249, v12
    v_mov_b32 v250, v12
    v_mov_b32 v251, v12
    v_mov_b32 v252, v12
    v_mov_b32 v253, v12
    v_mov_b32 v254, v12
    v_mov_b32 v255, v12
    v_mov_b32 v48, 0
    v_mov_b32 v49, 0
    v_mov_b32 v50, 0
    v_mov_b32 v51, 0
    v_mov_b32 v52, 0
    v_mov_b32 v53, 0
    v_mov_b32 v54, 0
    v_mov_b32 v55, 0
    v_and_b32 v12, 2, v0
    v_cmp_eq_u32 vcc, 0, v12
    v_mov_b32 v12, 0x3f803f80
    v_and_b32 v13, 1, v0
    v_cndmask_b32 v14, 0, v12, vcc
    v_cmp_eq_u32 vcc, 1, v13
    v_sub_u32 v15, v12, v14
    v_accvgpr_write_b32 a192, v14
    v_accvgpr_write_b32 a193, v14
    v_accvgpr_write_b32 a194, v14
    v_accvgpr_write_b32 a195, v14
    v_accvgpr_write_b32 a196, v15
    v_accvgpr_write_b32 a197, v15
    v_accvgpr_write_b32 a198, v15
    v_accvgpr_write_b32 a199, v15
    v_mov_b32 v11, 0x44444444
    v_mov_b32 v13, 0xeeeeeeee
    v_cndmask_b32 v11, v11, v13, vcc
    s_waitcnt vmcnt(8)
    v_subrev_co_u32 v56, vcc, s60, v56
    v_mov_b32 v15, s61
    s_nop 0
    v_subb_co_u32 v57, vcc, v57, v15, vcc
    v_lshrrev_b32 v56, 24, v56
    v_or_b32 v56, v56, v57
    v_subrev_co_u32 v58, vcc, s60, v58
    v_mov_b32 v15, s61
    s_nop 0
    v_subb_co_u32 v59, vcc, v59, v15, vcc
    v_lshrrev_b32 v58, 24, v58
    v_or_b32 v58, v58, v59
    v_or_b32 v56, v56, v58
    v_cmp_ne_u32 vcc, 0, v56
    s_nop 0
    s_cmp_lg_u64 vcc, 0
    s_cbranch_scc0 L_go
    s_call_b64 s[64:65], L_poll
    s_cbranch_scc1 L_redo
L_go:
    s_mov_b32 s25, 0x100000
    s_mov_b32 s98, 0xc2000000
    s_lshl_b32 s22, s20, 12
    s_and_b32 m0, s22, 0x1ffff
    s_nop 0
    buffer_load_dwordx4 v1, s[12:15], s22 offen offset:0 sc1 lds
    buffer_load_dwordx4 v1, s[12:15], s22 offen offset:1024 sc1 lds
    buffer_load_dwordx4 v1, s[12:15], s22 offen offset:2048 sc1 lds
    buffer_load_dwordx4 v1, s[12:15], s22 offen offset:3072 sc1 lds
    s_add_u32 s22, s22, 0x4000
    s_and_b32 m0, s22, 0x1ffff
    s_nop 0
    buffer_load_dwordx4 v1, s[12:15], s22 offen offset:0 sc1 lds
    buffer_load_dwordx4 v1, s[12:15], s22 offen offset:1024 sc1 lds
    buffer_load_dwordx4 v1, s[12:15], s22 offen offset:2048 sc1 lds
    buffer_load_dwordx4 v1, s[12:15], s22 offen offset:3072 sc1 lds
    s_add_u32 s22, s22, 0x4000
    s_and_b32 m0, s22, 0x1ffff
    s_nop 0
    buffer_load_dwordx4 v1, s[12:15], s22 offen offset:0 sc1 lds
    buffer_load_dwordx4 v1, s[12:15], s22 offen offset:1024 sc1 lds
    buffer_load_dwordx4 v1, s[12:15], s22 offen offset:2048 sc1 lds
    buffer_load_dwordx4 v1, s[12:15], s22 offen offset:3072 sc1 lds
    s_add_u32 s22, s22, 0x4000
    s_and_b32 m0, s22, 0x1ffff
    s_nop 0
    buffer_load_dwordx4 v1, s[12:15], s22 offen offset:0 sc1 lds
    buffer_load_dwordx4 v1, s[12:15], s22 offen offset:1024 sc1 lds
    buffer_load_dwordx4 v1, s[12:15], s22 offen offset:2048 sc1 lds
    buffer_load_dwordx4 v1, s[12:15], s22 offen offset:3072 sc1 lds
    s_waitcnt vmcnt(8) lgkmcnt(0)
    s_barrier
    ds_read_b128 a[64:67], v3 offset:0
    ds_read_b128 a[68:71], v3 offset:1024
    ds_read_b128 a[72:75], v3 offset:2048
    ds_read_b128 a[76:79], v3 offset:3072
    ds_read_b128 a[80:83], v3 offset:4096
    ds_read_b128 a[84:87], v3 offset:5120
    ds_read_b128 a[88:91], v3 offset:6144
    ds_read_b128 a[92:95], v3 offset:7168
    ds_read_b128 a[96:99], v3 offset:16384
    ds_read_b128 a[100:103], v3 offset:17408
    ds_read_b128 a[104:107], v3 offset:18432
    ds_read_b128 a[108:111], v3 offset:19456
    ds_read_b128 a[112:115], v3 offset:20480
    ds_read_b128 a[116:119], v3 offset:21504
    ds_read_b128 a[120:123], v3 offset:22528
    s_waitcnt lgkmcnt(14)
    v_mfma_f32_16x16x32_bf16 v[64:67], a[64:67], a[0:3], 0
    ds_read_b128 a[124:127], v3 offset:23552
    s_waitcnt lgkmcnt(14)
    v_mfma_f32_16x16x32_bf16 v[64:67], a[68:71], a[4:7], v[64:67]
    s_add_u32 s22, s22, 0x4000
    s_and_b32 m0, s22, 0x1ffff
    s_nop 0
    buffer_load_dwordx4 v1, s[12:15], s22 offen offset:0 sc1 lds
    s_waitcnt lgkmcnt(13)
    v_mfma_f32_16x16x32_bf16 v[64:67], a[72:75], a[8:11], v[64:67]
    s_waitcnt lgkmcnt(12)
    v_mfma_f32_16x16x32_bf16 v[64:67], a[76:79], a[12:15], v[64:67]
    buffer_load_dwordx4 v1, s[12:15], s22 offen offset:1024 sc1 lds
    v_mfma_f32_16x16x32_bf16 v[80:83], a[76:79], a[28:31], 0
    ds_read_b128 a[128:131], v2 offset:8192
    v_mfma_f32_16x16x32_bf16 v[80:83], a[72:75], a[24:27], v[80:83]
    ds_read_b128 a[132:135], v2 offset:24576
    buffer_load_dwordx4 v1, s[12:15], s22 offen offset:2048 sc1 lds
    v_mfma_f32_16x16x32_bf16 v[80:83], a[68:71], a[20:23], v[80:83]
    ds_read_b128 a[136:139], v2 offset:9216
    v_mfma_f32_16x16x32_bf16 v[80:83], a[64:67], a[16:19], v[80:83]
    ds_read_b128 a[140:143], v2 offset:25600
    buffer_load_dwordx4 v1, s[12:15], s22 offen offset:3072 sc1 lds
    v_mfma_f32_16x16x32_bf16 v[96:99], a[64:67], a[32:35], 0
    ds_read_b128 a[144:147], v2 offset:10240
    v_mfma_f32_16x16x32_bf16 v[96:99], a[68:71], a[36:39], v[96:99]
    ds_read_b128 a[148:151], v2 offset:26624
    s_add_u32 s22, s22, 0x4000
    s_and_b32 m0, s22, 0x1ffff
    s_nop 0
    buffer_load_dwordx4 v1, s[12:15], s22 offen offset:0 sc1 lds
    v_mfma_f32_16x16x32_bf16 v[96:99], a[72:75], a[40:43], v[96:99]
    ds_read_b128 a[152:155], v2 offset:11264
    v_mfma_f32_16x16x32_bf16 v[96:99], a[76:79], a[44:47], v[96:99]
    ds_read_b128 a[156:159], v2 offset:27648
    buffer_load_dwordx4 v1, s[12:15], s22 offen offset:1024 sc1 lds
    v_mfma_f32_16x16x32_bf16 v[112:115], a[76:79], a[60:63], 0
    ds_read_b128 a[160:163], v2 offset:12288
    v_mfma_f32_16x16x32_bf16 v[112:115], a[72:75], a[56:59], v[112:115]
    ds_read_b128 a[164:167], v2 offset:28672
    buffer_load_dwordx4 v1, s[12:15], s22 offen offset:2048 sc1 lds
    v_mfma_f32_16x16x32_bf16 v[112:115], a[68:71], a[52:55], v[112:115]
    ds_read_b128 a[168:171], v2 offset:13312
    v_mfma_f32_16x16x32_bf16 v[112:115], a[64:67], a[48:51], v[112:115]
    buffer_load_dwordx4 v1, s[12:15], s22 offen offset:3072 sc1 lds
    v_max3_f32 v12, v64, v65, v66
    v_max_f32 v12, v12, v67
    v_max3_f32 v13, v80, v81, v82
    v_max_f32 v13, v13, v83
    v_max3_f32 v14, v96, v97, v98
    v_max_f32 v14, v14, v99
    s_nop 0
    v_max3_f32 v15, v112, v113, v114
    v_max_f32 v15, v15, v115
    v_mov_b32 v16, v12
    v_mov_b32 v17, v13
    v_mov_b32 v18, v14
    v_mov_b32 v19, v15
    v_permlane32_swap_b32 v12, v16
    v_permlane32_swap_b32 v13, v17
    v_permlane32_swap_b32 v14, v18
    v_permlane32_swap_b32 v15, v19
    v_max_f32 v12, v12, v16
    v_max_f32 v13, v13, v17
    v_max_f32 v14, v14, v18
    v_max_f32 v15, v15, v19
    v_mov_b32 v16, v12
    v_mov_b32 v17, v13
    v_mov_b32 v18, v14
    v_mov_b32 v19, v15
    v_permlane16_swap_b32 v12, v16
    v_permlane16_swap_b32 v13, v17
    v_permlane16_swap_b32 v14, v18
    v_permlane16_swap_b32 v15, v19
    v_max_f32 v12, v12, v16
    v_max_f32 v13, v13, v17
    v_max_f32 v14, v14, v18
    v_max_f32 v15, v15, v19
    v_sub_f32 v32, s98, v12
    v_sub_f32 v33, s98, v12
    v_sub_f32 v34, s98, v12
    v_sub_f32 v35, s98, v12
    v_sub_f32 v36, s98, v13
    v_sub_f32 v37, s98, v13
    v_sub_f32 v38, s98, v13
    v_sub_f32 v39, s98, v13
    s_waitcnt lgkmcnt(11)
    v_mfma_f32_16x16x32_bf16 v[68:71], a[92:95], a[12:15], v[32:35]
    ds_read_b128 a[172:175], v2 offset:29696
    v_sub_f32 v40, s98, v14
    v_sub_f32 v41, s98, v14
    v_mfma_f32_16x16x32_bf16 v[68:71], a[88:91], a[8:11], v[68:71]
    ds_read_b128 a[176:179], v2 offset:14336
    v_sub_f32 v42, s98, v14
    v_sub_f32 v43, s98, v14
    v_mfma_f32_16x16x32_bf16 v[68:71], a[84:87], a[4:7], v[68:71]
    ds_read_b128 a[180:183], v2 offset:30720
    v_sub_f32 v44, s98, v15
    v_sub_f32 v45, s98, v15
    v_mfma_f32_16x16x32_bf16 v[68:71], a[80:83], a[0:3], v[68:71]
    ds_read_b128 a[184:187], v2 offset:15360
    v_sub_f32 v46, s98, v15
    v_sub_f32 v47, s98, v15
    v_mfma_f32_16x16x32_bf16 v[84:87], a[80:83], a[16:19], v[36:39]
    ds_read_b128 a[188:191], v2 offset:31744
    v_add_f32 v64, v64, v32
    v_add_f32 v65, v65, v32
    v_mfma_f32_16x16x32_bf16 v[84:87], a[84:87], a[20:23], v[84:87]
    v_add_f32 v66, v66, v32
    v_add_f32 v67, v67, v32
    v_mfma_f32_16x16x32_bf16 v[84:87], a[88:91], a[24:27], v[84:87]
    v_add_f32 v80, v80, v36
    v_add_f32 v81, v81, v36
    v_mfma_f32_16x16x32_bf16 v[84:87], a[92:95], a[28:31], v[84:87]
    v_add_f32 v82, v82, v36
    v_add_f32 v83, v83, v36
    v_mfma_f32_16x16x32_bf16 v[88:91], a[96:99], a[16:19], v[36:39]
    v_add_f32 v96, v96, v40
    v_add_f32 v97, v97, v40
    v_mfma_f32_16x16x32_bf16 v[88:91], a[100:103], a[20:23], v[88:91]
    v_add_f32 v98, v98, v40
    v_add_f32 v99, v99, v40
    v_mfma_f32_16x16x32_bf16 v[88:91], a[104:107], a[24:27], v[88:91]
    v_add_f32 v112, v112, v44
    v_add_f32 v113, v113, v44
    v_mfma_f32_16x16x32_bf16 v[88:91], a[108:111], a[28:31], v[88:91]
    v_add_f32 v114, v114, v44
    v_add_f32 v115, v115, v44
    v_mfma_f32_16x16x32_bf16 v[92:95], a[124:127], a[28:31], v[36:39]
    v_exp_f32 v64, v64
    v_mfma_f32_16x16x32_bf16 v[92:95], a[120:123], a[24:27], v[92:95]
    v_exp_f32 v65, v65
    v_mfma_f32_16x16x32_bf16 v[92:95], a[116:119], a[20:23], v[92:95]
    v_exp_f32 v66, v66
    v_mfma_f32_16x16x32_bf16 v[92:95], a[112:115], a[16:19], v[92:95]
    v_cvt_pk_bf16_f32 v64, v64, v65
    v_mfma_f32_16x16x32_bf16 v[76:79], a[112:115], a[0:3], v[32:35]
    v_exp_f32 v67, v67
    v_mfma_f32_16x16x32_bf16 v[76:79], a[116:119], a[4:7], v[76:79]
    v_exp_f32 v68, v68
    v_mfma_f32_16x16x32_bf16 v[76:79], a[120:123], a[8:11], v[76:79]
    v_cvt_pk_bf16_f32 v65, v66, v67
    v_mfma_f32_16x16x32_bf16 v[76:79], a[124:127], a[12:15], v[76:79]
    v_exp_f32 v69, v69
    v_mfma_f32_16x16x32_bf16 v[72:75], a[108:111], a[12:15], v[32:35]
    v_exp_f32 v70, v70
    v_mfma_f32_16x16x32_bf16 v[72:75], a[104:107], a[8:11], v[72:75]
    v_cvt_pk_bf16_f32 v66, v68, v69
    v_mfma_f32_16x16x32_bf16 v[72:75], a[100:103], a[4:7], v[72:75]
    v_exp_f32 v71, v71
    v_mfma_f32_16x16x32_bf16 v[72:75], a[96:99], a[0:3], v[72:75]
    v_exp_f32 v80, v80
    v_mfma_f32_16x16x32_bf16 v[100:103], a[92:95], a[44:47], v[40:43]
    v_cvt_pk_bf16_f32 v67, v70, v71
    v_mfma_f32_16x16x32_bf16 v[100:103], a[88:91], a[40:43], v[100:103]
    v_exp_f32 v81, v81
    v_mfma_f32_16x16x32_bf16 v[100:103], a[84:87], a[36:39], v[100:103]
    v_exp_f32 v82, v82
    v_mfma_f32_16x16x32_bf16 v[100:103], a[80:83], a[32:35], v[100:103]
    v_cvt_pk_bf16_f32 v80, v80, v81
    v_mfma_f32_16x16x32_bf16 v[116:119], a[80:83], a[48:51], v[44:47]
    v_exp_f32 v83, v83
    v_mfma_f32_16x16x32_bf16 v[116:119], a[84:87], a[52:55], v[116:119]
    v_exp_f32 v84, v84
    v_mfma_f32_16x16x32_bf16 v[116:119], a[88:91], a[56:59], v[116:119]
    v_cvt_pk_bf16_f32 v81, v82, v83
    v_mfma_f32_16x16x32_bf16 v[116:119], a[92:95], a[60:63], v[116:119]
    v_exp_f32 v85, v85
    v_mfma_f32_16x16x32_bf16 v[120:123], a[96:99], a[48:51], v[44:47]
    v_exp_f32 v86, v86
    v_mfma_f32_16x16x32_bf16 v[120:123], a[100:103], a[52:55], v[120:123]
    v_cvt_pk_bf16_f32 v82, v84, v85
    v_mfma_f32_16x16x32_bf16 v[120:123], a[104:107], a[56:59], v[120:123]
    v_exp_f32 v87, v87
    v_mfma_f32_16x16x32_bf16 v[120:123], a[108:111], a[60:63], v[120:123]
    v_exp_f32 v88, v88
    v_mfma_f32_16x16x32_bf16 v[124:127], a[124:127], a[60:63], v[44:47]
    v_cvt_pk_bf16_f32 v83, v86, v87
    v_mfma_f32_16x16x32_bf16 v[124:127], a[120:123], a[56:59], v[124:127]
    v_exp_f32 v89, v89
    v_mfma_f32_16x16x32_bf16 v[124:127], a[116:119], a[52:55], v[124:127]
    v_exp_f32 v90, v90
    v_mfma_f32_16x16x32_bf16 v[124:127], a[112:115], a[48:51], v[124:127]
    v_cvt_pk_bf16_f32 v84, v88, v89
    v_mfma_f32_16x16x32_bf16 v[108:111], a[112:115], a[32:35], v[40:43]
    v_exp_f32 v91, v91
    v_mfma_f32_16x16x32_bf16 v[108:111], a[116:119], a[36:39], v[108:111]
    v_exp_f32 v92, v92
    v_mfma_f32_16x16x32_bf16 v[108:111], a[120:123], a[40:43], v[108:111]
    v_cvt_pk_bf16_f32 v85, v90, v91
    v_mfma_f32_16x16x32_bf16 v[108:111], a[124:127], a[44:47], v[108:111]
    v_exp_f32 v93, v93
    v_mfma_f32_16x16x32_bf16 v[104:107], a[108:111], a[44:47], v[40:43]
    v_exp_f32 v94, v94
    v_mfma_f32_16x16x32_bf16 v[104:107], a[104:107], a[40:43], v[104:107]
    v_cvt_pk_bf16_f32 v86, v92, v93
    v_mfma_f32_16x16x32_bf16 v[104:107], a[100:103], a[36:39], v[104:107]
    v_exp_f32 v95, v95
    v_mfma_f32_16x16x32_bf16 v[104:107], a[96:99], a[32:35], v[104:107]
    v_exp_f32 v72, v72
    v_cvt_pk_bf16_f32 v87, v94, v95
    v_exp_f32 v73, v73
    v_exp_f32 v74, v74
    v_cvt_pk_bf16_f32 v68, v72, v73
    v_exp_f32 v75, v75
    v_exp_f32 v76, v76
    v_cvt_pk_bf16_f32 v69, v74, v75
    v_exp_f32 v77, v77
    v_exp_f32 v78, v78
    v_cvt_pk_bf16_f32 v70, v76, v77
    v_exp_f32 v79, v79
    s_nop 0
    v_cvt_pk_bf16_f32 v71, v78, v79
    v_exp_f32 v96, v96
    v_exp_f32 v97, v97
    v_exp_f32 v98, v98
    v_cvt_pk_bf16_f32 v96, v96, v97
    v_exp_f32 v99, v99
    v_add_u32 v3, 0x8000, v3
    s_waitcnt vmcnt(8) lgkmcnt(0)
    s_barrier
    s_getpc_b64 s[64:65]
L_pc:
    s_add_u32 s64, s64, L_loop-L_pc
    s_addc_u32 s65, s65, 0
    s_branch L_entry
.p2align 6
L_loop:
    v_mfma_f32_16x16x32_bf16 v[92:95], a[124:127], a[28:31], v[36:39]
    v_exp_f32 v110, v110
    v_mfma_f32_16x16x32_bf16 v[92:95], a[120:123], a[24:27], v[92:95]
    s_add_u32 s24, s24, 1
    v_cvt_pk_bf16_f32 v102, v108, v109
    v_mfma_f32_16x16x32_bf16 v[92:95], a[116:119], a[20:23], v[92:95]
    v_exp_f32 v111, v111
    v_mfma_f32_16x16x32_bf16 v[92:95], a[112:115], a[16:19], v[92:95]
    buffer_load_dwordx4 v1, s[12:15], s22 offen offset:0 sc1 lds
    v_mfma_f32_16x16x32_bf16 v[76:79], a[112:115], a[0:3], v[32:35]
    v_exp_f32 v64, v64
    v_mfma_f32_16x16x32_bf16 v[76:79], a[116:119], a[4:7], v[76:79]
    v_cvt_pk_bf16_f32 v103, v110, v111
    v_mfma_f32_16x16x32_bf16 v[76:79], a[120:123], a[8:11], v[76:79]
    v_exp_f32 v65, v65
    v_mfma_f32_16x16x32_bf16 v[76:79], a[124:127], a[12:15], v[76:79]
    buffer_load_dwordx4 v1, s[12:15], s22 offen offset:1024 sc1 lds
    v_mfma_f32_16x16x32_bf16 v[72:75], a[108:111], a[12:15], v[32:35]
    v_exp_f32 v66, v66
    v_mfma_f32_16x16x32_bf16 v[72:75], a[104:107], a[8:11], v[72:75]
    v_cvt_pk_bf16_f32 v64, v64, v65
    v_mfma_f32_16x16x32_bf16 v[72:75], a[100:103], a[4:7], v[72:75]
    v_exp_f32 v67, v67
    v_mfma_f32_16x16x32_bf16 v[72:75], a[96:99], a[0:3], v[72:75]
    v_mfma_f32_16x16x32_bf16 v[192:195], v[96:99], a[128:131], v[192:195]
    v_exp_f32 v68, v68
    v_mfma_f32_16x16x32_bf16 v[192:195], v[100:103], a[132:135], v[192:195]
    v_cvt_pk_bf16_f32 v65, v66, v67
    v_mfma_f32_16x16x32_bf16 v[196:199], v[100:103], a[140:143], v[196:199]
    v_exp_f32 v69, v69
    v_mfma_f32_16x16x32_bf16 v[196:199], v[96:99], a[136:139], v[196:199]
    buffer_load_dwordx4 v1, s[12:15], s22 offen offset:2048 sc1 lds
    v_mfma_f32_16x16x32_bf16 v[200:203], v[96:99], a[144:147], v[200:203]
    v_exp_f32 v70, v70
    v_mfma_f32_16x16x32_bf16 v[200:203], v[100:103], a[148:151], v[200:203]
    v_cvt_pk_bf16_f32 v66, v68, v69
    v_smfmac_f32_16x16x64_bf16 v[52:55], a[196:199], v[112:119], v11
    v_smfmac_f32_16x16x64_bf16 v[52:55], a[192:195], v[96:103], v11
    buffer_load_dwordx4 v1, s[12:15], s22 offen offset:3072 sc1 lds
    v_mfma_f32_16x16x32_bf16 v[204:207], v[100:103], a[156:159], v[204:207]
    v_exp_f32 v71, v71
    v_mfma_f32_16x16x32_bf16 v[204:207], v[96:99], a[152:155], v[204:207]
    s_add_u32 s22, s22, 0x4000
    v_mfma_f32_16x16x32_bf16 v[236:239], v[112:115], a[152:155], v[236:239]
    v_exp_f32 v80, v80
    v_mfma_f32_16x16x32_bf16 v[236:239], v[116:119], a[156:159], v[236:239]
    s_and_b32 m0, s22, 0x1ffff
    v_cvt_pk_bf16_f32 v67, v70, v71
    v_mfma_f32_16x16x32_bf16 v[232:235], v[116:119], a[148:151], v[232:235]
    v_exp_f32 v81, v81
    v_mfma_f32_16x16x32_bf16 v[232:235], v[112:115], a[144:147], v[232:235]
    buffer_load_dwordx4 v1, s[12:15], s22 offen offset:0 sc1 lds
    v_mfma_f32_16x16x32_bf16 v[228:231], v[112:115], a[136:139], v[228:231]
    v_exp_f32 v82, v82
    v_mfma_f32_16x16x32_bf16 v[228:231], v[116:119], a[140:143], v[228:231]
    ds_read_b32 v9, v8
    v_cvt_pk_bf16_f32 v80, v80, v81
    v_mfma_f32_16x16x32_bf16 v[224:227], v[116:119], a[132:135], v[224:227]
    v_exp_f32 v83, v83
    v_mfma_f32_16x16x32_bf16 v[224:227], v[112:115], a[128:131], v[224:227]
    v_mfma_f32_16x16x32_bf16 v[240:243], v[112:115], a[160:163], v[240:243]
    v_exp_f32 v84, v84
    v_mfma_f32_16x16x32_bf16 v[240:243], v[116:119], a[164:167], v[240:243]
    v_cvt_pk_bf16_f32 v81, v82, v83
    v_mfma_f32_16x16x32_bf16 v[244:247], v[116:119], a[172:175], v[244:247]
    v_exp_f32 v85, v85
    v_mfma_f32_16x16x32_bf16 v[244:247], v[112:115], a[168:171], v[244:247]
    buffer_load_dwordx4 v1, s[12:15], s22 offen offset:1024 sc1 lds
    v_mfma_f32_16x16x32_bf16 v[248:251], v[112:115], a[176:179], v[248:251]
    v_exp_f32 v86, v86
    v_mfma_f32_16x16x32_bf16 v[248:251], v[116:119], a[180:183], v[248:251]
    v_cvt_pk_bf16_f32 v82, v84, v85
    v_mfma_f32_16x16x32_bf16 v[252:255], v[116:119], a[188:191], v[252:255]
    v_exp_f32 v87, v87
    v_mfma_f32_16x16x32_bf16 v[252:255], v[112:115], a[184:187], v[252:255]
    buffer_load_dwordx4 v1, s[12:15], s22 offen offset:2048 sc1 lds
    v_mfma_f32_16x16x32_bf16 v[220:223], v[96:99], a[184:187], v[220:223]
    v_exp_f32 v88, v88
    v_mfma_f32_16x16x32_bf16 v[220:223], v[100:103], a[188:191], v[220:223]
    s_waitcnt lgkmcnt(0)
    v_cvt_pk_bf16_f32 v83, v86, v87
    v_mfma_f32_16x16x32_bf16 v[216:219], v[100:103], a[180:183], v[216:219]
    v_exp_f32 v89, v89
    v_mfma_f32_16x16x32_bf16 v[216:219], v[96:99], a[176:179], v[216:219]
    buffer_load_dwordx4 v1, s[12:15], s22 offen offset:3072 sc1 lds
    v_mfma_f32_16x16x32_bf16 v[212:215], v[96:99], a[168:171], v[212:215]
    v_exp_f32 v90, v90
    v_mfma_f32_16x16x32_bf16 v[212:215], v[100:103], a[172:175], v[212:215]
    v_cmp_gt_u32 vcc, v7, v9
    v_cvt_pk_bf16_f32 v84, v88, v89
    v_mfma_f32_16x16x32_bf16 v[208:211], v[100:103], a[164:167], v[208:211]
    v_exp_f32 v91, v91
    v_mfma_f32_16x16x32_bf16 v[208:211], v[96:99], a[160:163], v[208:211]
    s_cbranch_vccnz L_spin
L_spin_ret:
    v_mfma_f32_16x16x32_bf16 v[96:99], a[64:67], a[32:35], v[40:43]
    v_exp_f32 v92, v92
    v_mfma_f32_16x16x32_bf16 v[96:99], a[68:71], a[36:39], v[96:99]
    ds_read_b128 a[128:131], v2 offset:8192
    v_cvt_pk_bf16_f32 v85, v90, v91
    v_mfma_f32_16x16x32_bf16 v[96:99], a[72:75], a[40:43], v[96:99]
    v_exp_f32 v93, v93
    v_mfma_f32_16x16x32_bf16 v[96:99], a[76:79], a[44:47], v[96:99]
    ds_read_b128 a[132:135], v2 offset:24576
    s_cmp_eq_u32 s24, 31
    v_mfma_f32_16x16x32_bf16 v[100:103], a[92:95], a[44:47], v[40:43]
    v_exp_f32 v94, v94
    v_mfma_f32_16x16x32_bf16 v[100:103], a[88:91], a[40:43], v[100:103]
    ds_read_b128 a[136:139], v2 offset:9216
    v_cvt_pk_bf16_f32 v86, v92, v93
    v_mfma_f32_16x16x32_bf16 v[100:103], a[84:87], a[36:39], v[100:103]
    v_exp_f32 v95, v95
    v_mfma_f32_16x16x32_bf16 v[100:103], a[80:83], a[32:35], v[100:103]
    ds_read_b128 a[140:143], v2 offset:25600
    v_mfma_f32_16x16x32_bf16 v[116:119], a[80:83], a[48:51], v[44:47]
    v_exp_f32 v72, v72
    v_mfma_f32_16x16x32_bf16 v[116:119], a[84:87], a[52:55], v[116:119]
    ds_read_b128 a[144:147], v2 offset:10240
    v_cvt_pk_bf16_f32 v87, v94, v95
    v_mfma_f32_16x16x32_bf16 v[116:119], a[88:91], a[56:59], v[116:119]
    v_exp_f32 v73, v73
    v_mfma_f32_16x16x32_bf16 v[116:119], a[92:95], a[60:63], v[116:119]
    ds_read_b128 a[148:151], v2 offset:26624
    v_mfma_f32_16x16x32_bf16 v[112:115], a[76:79], a[60:63], v[44:47]
    v_exp_f32 v74, v74
    v_mfma_f32_16x16x32_bf16 v[112:115], a[72:75], a[56:59], v[112:115]
    ds_read_b128 a[152:155], v2 offset:11264
    v_cvt_pk_bf16_f32 v68, v72, v73
    v_mfma_f32_16x16x32_bf16 v[112:115], a[68:71], a[52:55], v[112:115]
    v_exp_f32 v75, v75
    v_mfma_f32_16x16x32_bf16 v[112:115], a[64:67], a[48:51], v[112:115]
    ds_read_b128 a[156:159], v2 offset:27648
    v_mfma_f32_16x16x32_bf16 v[120:123], a[96:99], a[48:51], v[44:47]
    v_exp_f32 v76, v76
    v_mfma_f32_16x16x32_bf16 v[120:123], a[100:103], a[52:55], v[120:123]
    ds_read_b128 a[160:163], v2 offset:12288
    v_cvt_pk_bf16_f32 v69, v74, v75
    v_mfma_f32_16x16x32_bf16 v[120:123], a[104:107], a[56:59], v[120:123]
    v_exp_f32 v77, v77
    v_mfma_f32_16x16x32_bf16 v[120:123], a[108:111], a[60:63], v[120:123]
    ds_read_b128 a[164:167], v2 offset:28672
    v_mfma_f32_16x16x32_bf16 v[124:127], a[124:127], a[60:63], v[44:47]
    v_exp_f32 v78, v78
    v_mfma_f32_16x16x32_bf16 v[124:127], a[120:123], a[56:59], v[124:127]
    ds_read_b128 a[168:171], v2 offset:13312
    v_cvt_pk_bf16_f32 v70, v76, v77
    v_mfma_f32_16x16x32_bf16 v[124:127], a[116:119], a[52:55], v[124:127]
    v_exp_f32 v79, v79
    v_mfma_f32_16x16x32_bf16 v[124:127], a[112:115], a[48:51], v[124:127]
    ds_read_b128 a[172:175], v2 offset:29696
    v_mfma_f32_16x16x32_bf16 v[108:111], a[112:115], a[32:35], v[40:43]
    v_exp_f32 v96, v96
    v_mfma_f32_16x16x32_bf16 v[108:111], a[116:119], a[36:39], v[108:111]
    ds_read_b128 a[176:179], v2 offset:14336
    v_cvt_pk_bf16_f32 v71, v78, v79
    v_mfma_f32_16x16x32_bf16 v[108:111], a[120:123], a[40:43], v[108:111]
    v_exp_f32 v97, v97
    v_mfma_f32_16x16x32_bf16 v[108:111], a[124:127], a[44:47], v[108:111]
    ds_read_b128 a[180:183], v2 offset:30720
    v_mfma_f32_16x16x32_bf16 v[104:107], a[108:111], a[44:47], v[40:43]
    v_exp_f32 v98, v98
    v_mfma_f32_16x16x32_bf16 v[104:107], a[104:107], a[40:43], v[104:107]
    ds_read_b128 a[184:187], v2 offset:15360
    v_cvt_pk_bf16_f32 v96, v96, v97
    v_mfma_f32_16x16x32_bf16 v[104:107], a[100:103], a[36:39], v[104:107]
    v_exp_f32 v99, v99
    v_mfma_f32_16x16x32_bf16 v[104:107], a[96:99], a[32:35], v[104:107]
    ds_read_b128 a[188:191], v2 offset:31744
    s_waitcnt lgkmcnt(8)
    s_cbranch_scc1 L_tail
L_entry:
    v_mfma_f32_16x16x32_bf16 v[128:131], v[64:67], a[128:131], v[128:131]
    v_exp_f32 v100, v100
    v_mfma_f32_16x16x32_bf16 v[128:131], v[68:71], a[132:135], v[128:131]
    ds_read_b128 a[64:67], v3 offset:0
    v_cvt_pk_bf16_f32 v97, v98, v99
    v_mfma_f32_16x16x32_bf16 v[132:135], v[68:71], a[140:143], v[132:135]
    v_exp_f32 v101, v101
    v_mfma_f32_16x16x32_bf16 v[132:135], v[64:67], a[136:139], v[132:135]
    ds_read_b128 a[68:71], v3 offset:1024
    v_mfma_f32_16x16x32_bf16 v[136:139], v[64:67], a[144:147], v[136:139]
    v_exp_f32 v102, v102
    v_mfma_f32_16x16x32_bf16 v[136:139], v[68:71], a[148:151], v[136:139]
    ds_read_b128 a[72:75], v3 offset:2048
    v_cvt_pk_bf16_f32 v98, v100, v101
    v_mfma_f32_16x16x32_bf16 v[140:143], v[68:71], a[156:159], v[140:143]
    v_exp_f32 v103, v103
    v_mfma_f32_16x16x32_bf16 v[140:143], v[64:67], a[152:155], v[140:143]
    ds_read_b128 a[76:79], v3 offset:3072
    v_mfma_f32_16x16x32_bf16 v[172:175], v[80:83], a[152:155], v[172:175]
    v_exp_f32 v112, v112
    v_mfma_f32_16x16x32_bf16 v[172:175], v[84:87], a[156:159], v[172:175]
    ds_read_b128 a[80:83], v3 offset:4096
    v_cvt_pk_bf16_f32 v99, v102, v103
    v_smfmac_f32_16x16x64_bf16 v[48:51], a[196:199], v[80:87], v11
    v_smfmac_f32_16x16x64_bf16 v[48:51], a[192:195], v[64:71], v11
    v_mfma_f32_16x16x32_bf16 v[168:171], v[84:87], a[148:151], v[168:171]
    v_exp_f32 v113, v113
    v_mfma_f32_16x16x32_bf16 v[168:171], v[80:83], a[144:147], v[168:171]
    ds_read_b128 a[84:87], v3 offset:5120
    v_mfma_f32_16x16x32_bf16 v[164:167], v[80:83], a[136:139], v[164:167]
    v_exp_f32 v114, v114
    v_mfma_f32_16x16x32_bf16 v[164:167], v[84:87], a[140:143], v[164:167]
    ds_read_b128 a[88:91], v3 offset:6144
    v_cvt_pk_bf16_f32 v112, v112, v113
    v_mfma_f32_16x16x32_bf16 v[160:163], v[84:87], a[132:135], v[160:163]
    v_exp_f32 v115, v115
    v_mfma_f32_16x16x32_bf16 v[160:163], v[80:83], a[128:131], v[160:163]
    ds_read_b128 a[92:95], v3 offset:7168
    s_waitcnt lgkmcnt(8)
    v_mfma_f32_16x16x32_bf16 v[176:179], v[80:83], a[160:163], v[176:179]
    v_exp_f32 v116, v116
    v_mfma_f32_16x16x32_bf16 v[176:179], v[84:87], a[164:167], v[176:179]
    ds_read_b128 a[96:99], v3 offset:16384
    v_cvt_pk_bf16_f32 v113, v114, v115
    v_mfma_f32_16x16x32_bf16 v[180:183], v[84:87], a[172:175], v[180:183]
    v_exp_f32 v117, v117
    v_mfma_f32_16x16x32_bf16 v[180:183], v[80:83], a[168:171], v[180:183]
    ds_read_b128 a[100:103], v3 offset:17408
    v_mfma_f32_16x16x32_bf16 v[184:187], v[80:83], a[176:179], v[184:187]
    v_exp_f32 v118, v118
    v_mfma_f32_16x16x32_bf16 v[184:187], v[84:87], a[180:183], v[184:187]
    ds_read_b128 a[104:107], v3 offset:18432
    v_cvt_pk_bf16_f32 v114, v116, v117
    v_mfma_f32_16x16x32_bf16 v[188:191], v[84:87], a[188:191], v[188:191]
    v_exp_f32 v119, v119
    v_mfma_f32_16x16x32_bf16 v[188:191], v[80:83], a[184:187], v[188:191]
    ds_read_b128 a[108:111], v3 offset:19456
    v_mfma_f32_16x16x32_bf16 v[156:159], v[64:67], a[184:187], v[156:159]
    v_exp_f32 v120, v120
    v_mfma_f32_16x16x32_bf16 v[156:159], v[68:71], a[188:191], v[156:159]
    ds_read_b128 a[112:115], v3 offset:20480
    v_cvt_pk_bf16_f32 v115, v118, v119
    v_mfma_f32_16x16x32_bf16 v[152:155], v[68:71], a[180:183], v[152:155]
    v_exp_f32 v121, v121
    v_mfma_f32_16x16x32_bf16 v[152:155], v[64:67], a[176:179], v[152:155]
    ds_read_b128 a[116:119], v3 offset:21504
    v_mfma_f32_16x16x32_bf16 v[148:151], v[64:67], a[168:171], v[148:151]
    v_exp_f32 v122, v122
    v_mfma_f32_16x16x32_bf16 v[148:151], v[68:71], a[172:175], v[148:151]
    ds_read_b128 a[120:123], v3 offset:22528
    v_cvt_pk_bf16_f32 v116, v120, v121
    v_mfma_f32_16x16x32_bf16 v[144:147], v[68:71], a[164:167], v[144:147]
    v_exp_f32 v123, v123
    v_mfma_f32_16x16x32_bf16 v[144:147], v[64:67], a[160:163], v[144:147]
    ds_read_b128 a[124:127], v3 offset:23552
    s_waitcnt lgkmcnt(8)
    v_mfma_f32_16x16x32_bf16 v[64:67], a[64:67], a[0:3], v[32:35]
    v_exp_f32 v124, v124
    v_mfma_f32_16x16x32_bf16 v[64:67], a[68:71], a[4:7], v[64:67]
    v_mov_b32 v2, v3
    v_cvt_pk_bf16_f32 v117, v122, v123
    v_mfma_f32_16x16x32_bf16 v[64:67], a[72:75], a[8:11], v[64:67]
    v_exp_f32 v125, v125
    v_mfma_f32_16x16x32_bf16 v[64:67], a[76:79], a[12:15], v[64:67]
    s_add_u32 s22, s22, 0x4000
    v_add_u32 v7, 1, v7
    v_mfma_f32_16x16x32_bf16 v[68:71], a[92:95], a[12:15], v[32:35]
    v_exp_f32 v126, v126
    v_mfma_f32_16x16x32_bf16 v[68:71], a[88:91], a[8:11], v[68:71]
    s_and_b32 m0, s22, 0x1ffff
    v_cvt_pk_bf16_f32 v118, v124, v125
    v_mfma_f32_16x16x32_bf16 v[68:71], a[84:87], a[4:7], v[68:71]
    v_exp_f32 v127, v127
    v_mfma_f32_16x16x32_bf16 v[68:71], a[80:83], a[0:3], v[68:71]
    s_bitcmp1_b32 s35, s24
    v_mfma_f32_16x16x32_bf16 v[84:87], a[80:83], a[16:19], v[36:39]
    v_exp_f32 v104, v104
    v_mfma_f32_16x16x32_bf16 v[84:87], a[84:87], a[20:23], v[84:87]
    v_add_u32 v3, 0x8000, v3
    v_cvt_pk_bf16_f32 v119, v126, v127
    v_mfma_f32_16x16x32_bf16 v[84:87], a[88:91], a[24:27], v[84:87]
    v_exp_f32 v105, v105
    v_mfma_f32_16x16x32_bf16 v[84:87], a[92:95], a[28:31], v[84:87]
    v_and_b32 v3, 0x1ffff, v3
    v_mfma_f32_16x16x32_bf16 v[80:83], a[76:79], a[28:31], v[36:39]
    v_exp_f32 v106, v106
    v_mfma_f32_16x16x32_bf16 v[80:83], a[72:75], a[24:27], v[80:83]
    v_cvt_pk_bf16_f32 v100, v104, v105
    v_mfma_f32_16x16x32_bf16 v[80:83], a[68:71], a[20:23], v[80:83]
    v_exp_f32 v107, v107
    v_mfma_f32_16x16x32_bf16 v[80:83], a[64:67], a[16:19], v[80:83]
    s_waitcnt lgkmcnt(0)
    v_mfma_f32_16x16x32_bf16 v[88:91], a[96:99], a[16:19], v[36:39]
    v_exp_f32 v108, v108
    v_mfma_f32_16x16x32_bf16 v[88:91], a[100:103], a[20:23], v[88:91]
    s_waitcnt vmcnt(0)
    v_cvt_pk_bf16_f32 v101, v106, v107
    v_mfma_f32_16x16x32_bf16 v[88:91], a[104:107], a[24:27], v[88:91]
    v_exp_f32 v109, v109
    v_mfma_f32_16x16x32_bf16 v[88:91], a[108:111], a[28:31], v[88:91]
    ds_write_b32 v6, v7
    s_cbranch_scc0 L_loop
    s_sub_u32 s3, s24, 1
    s_cmp_gt_u32 s3, 2
    s_cbranch_scc0 L_uproc
    s_branch L_hook_s
L_hook_w:
    s_cmp_eq_u32 s24, 0
    s_cbranch_scc1 L_uload
    buffer_wbl2 sc1
    s_branch L_loop
L_hook_s:
    s_cmp_gt_u32 s3, 10
    s_cbranch_scc1 L_hook_w
    s_bitcmp1_b32 s24, 0
    s_cbranch_scc1 L_hook_c
    s_add_u32 s100, s100, 0x4000
    buffer_load_dwordx4 v[56:59], v1, s[4:7], s100 offen sc1
    s_cmp_eq_u32 s24, 4
    s_cbranch_scc1 L_flag_n
    s_branch L_loop
L_hook_c:
    v_subrev_co_u32 v56, vcc, s60, v56
    v_mov_b32 v15, s61
    s_nop 0
    v_subb_co_u32 v57, vcc, v57, v15, vcc
    v_lshrrev_b32 v56, 24, v56
    v_or_b32 v56, v56, v57
    v_subrev_co_u32 v58, vcc, s60, v58
    v_mov_b32 v15, s61
    s_nop 0
    v_subb_co_u32 v59, vcc, v59, v15, vcc
    v_lshrrev_b32 v58, 24, v58
    v_or_b32 v58, v58, v59
    v_or_b32 v56, v56, v58
    v_cmp_ne_u32 vcc, 0, v56
    s_nop 0
    s_cmp_lg_u64 vcc, 0
    s_cbranch_scc0 L_loop
    s_cmp_lg_u32 s43, 0
    s_cbranch_scc1 L_loop
    s_branch L_poll
L_tail:
    v_smfmac_f32_16x16x64_bf16 v[48:51], a[192:195], v[64:71], v11
    v_smfmac_f32_16x16x64_bf16 v[48:51], a[196:199], v[80:87], v11
    v_mfma_f32_16x16x32_bf16 v[128:131], v[64:67], a[128:131], v[128:131]
    v_exp_f32 v100, v100
    v_mfma_f32_16x16x32_bf16 v[128:131], v[68:71], a[132:135], v[128:131]
    v_cvt_pk_bf16_f32 v97, v98, v99
    v_mfma_f32_16x16x32_bf16 v[132:135], v[68:71], a[140:143], v[132:135]
    v_exp_f32 v101, v101
    v_mfma_f32_16x16x32_bf16 v[132:135], v[64:67], a[136:139], v[132:135]
    v_exp_f32 v102, v102
    v_mfma_f32_16x16x32_bf16 v[136:139], v[64:67], a[144:147], v[136:139]
    v_cvt_pk_bf16_f32 v98, v100, v101
    v_mfma_f32_16x16x32_bf16 v[136:139], v[68:71], a[148:151], v[136:139]
    v_exp_f32 v103, v103
    v_mfma_f32_16x16x32_bf16 v[140:143], v[68:71], a[156:159], v[140:143]
    v_exp_f32 v112, v112
    v_mfma_f32_16x16x32_bf16 v[140:143], v[64:67], a[152:155], v[140:143]
    v_cvt_pk_bf16_f32 v99, v102, v103
    v_mfma_f32_16x16x32_bf16 v[172:175], v[80:83], a[152:155], v[172:175]
    v_exp_f32 v113, v113
    v_mfma_f32_16x16x32_bf16 v[172:175], v[84:87], a[156:159], v[172:175]
    v_exp_f32 v114, v114
    v_mfma_f32_16x16x32_bf16 v[168:171], v[84:87], a[148:151], v[168:171]
    v_cvt_pk_bf16_f32 v112, v112, v113
    v_mfma_f32_16x16x32_bf16 v[168:171], v[80:83], a[144:147], v[168:171]
    v_exp_f32 v115, v115
    v_mfma_f32_16x16x32_bf16 v[164:167], v[80:83], a[136:139], v[164:167]
    v_exp_f32 v116, v116
    v_mfma_f32_16x16x32_bf16 v[164:167], v[84:87], a[140:143], v[164:167]
    v_cvt_pk_bf16_f32 v113, v114, v115
    v_mfma_f32_16x16x32_bf16 v[160:163], v[84:87], a[132:135], v[160:163]
    v_exp_f32 v117, v117
    v_mfma_f32_16x16x32_bf16 v[160:163], v[80:83], a[128:131], v[160:163]
    v_exp_f32 v118, v118
    s_waitcnt lgkmcnt(0)
    v_mfma_f32_16x16x32_bf16 v[176:179], v[80:83], a[160:163], v[176:179]
    v_cvt_pk_bf16_f32 v114, v116, v117
    v_mfma_f32_16x16x32_bf16 v[176:179], v[84:87], a[164:167], v[176:179]
    v_exp_f32 v119, v119
    v_mfma_f32_16x16x32_bf16 v[180:183], v[84:87], a[172:175], v[180:183]
    v_exp_f32 v120, v120
    v_mfma_f32_16x16x32_bf16 v[180:183], v[80:83], a[168:171], v[180:183]
    v_cvt_pk_bf16_f32 v115, v118, v119
    v_mfma_f32_16x16x32_bf16 v[184:187], v[80:83], a[176:179], v[184:187]
    v_exp_f32 v121, v121
    v_mfma_f32_16x16x32_bf16 v[184:187], v[84:87], a[180:183], v[184:187]
    v_exp_f32 v122, v122
    v_mfma_f32_16x16x32_bf16 v[188:191], v[84:87], a[188:191], v[188:191]
    v_cvt_pk_bf16_f32 v116, v120, v121
    v_mfma_f32_16x16x32_bf16 v[188:191], v[80:83], a[184:187], v[188:191]
    v_exp_f32 v123, v123
    v_mfma_f32_16x16x32_bf16 v[156:159], v[64:67], a[184:187], v[156:159]
    v_exp_f32 v124, v124
    v_mfma_f32_16x16x32_bf16 v[156:159], v[68:71], a[188:191], v[156:159]
    v_cvt_pk_bf16_f32 v117, v122, v123
    v_mfma_f32_16x16x32_bf16 v[152:155], v[68:71], a[180:183], v[152:155]
    v_exp_f32 v125, v125
    v_mfma_f32_16x16x32_bf16 v[152:155], v[64:67], a[176:179], v[152:155]
    v_exp_f32 v126, v126
    v_mfma_f32_16x16x32_bf16 v[148:151], v[64:67], a[168:171], v[148:151]
    v_cvt_pk_bf16_f32 v118, v124, v125
    v_mfma_f32_16x16x32_bf16 v[148:151], v[68:71], a[172:175], v[148:151]
    v_exp_f32 v127, v127
    v_mfma_f32_16x16x32_bf16 v[144:147], v[68:71], a[164:167], v[144:147]
    v_exp_f32 v104, v104
    v_mfma_f32_16x16x32_bf16 v[144:147], v[64:67], a[160:163], v[144:147]
    v_cvt_pk_bf16_f32 v119, v126, v127
    v_exp_f32 v105, v105
    v_exp_f32 v106, v106
    v_cvt_pk_bf16_f32 v100, v104, v105
    v_exp_f32 v107, v107
    v_exp_f32 v108, v108
    v_cvt_pk_bf16_f32 v101, v106, v107
    v_exp_f32 v109, v109
    v_exp_f32 v110, v110
    v_cvt_pk_bf16_f32 v102, v108, v109
    v_exp_f32 v111, v111
    s_nop 0
    v_cvt_pk_bf16_f32 v103, v110, v111
    v_lshrrev_b32 v16, 4, v0
    v_and_b32 v4, 15, v0
    v_lshlrev_b32 v4, 4, v4
    v_lshl_add_u32 v4, v16, 10, v4
    v_lshlrev_b32 v16, 4, v16
    v_add_u32 v17, 4, v16
    v_add_u32 v18, 8, v16
    v_add_u32 v19, 12, v16
    v_add_f32 v12, v48, v49
    v_add_f32 v13, v50, v51
    v_rcp_f32 v20, v12
    v_rcp_f32 v21, v13
    v_smfmac_f32_16x16x64_bf16 v[52:55], a[192:195], v[96:103], v11
    v_smfmac_f32_16x16x64_bf16 v[52:55], a[196:199], v[112:119], v11
    ds_bpermute_b32 v24, v16, v20
    ds_bpermute_b32 v25, v17, v20
    ds_bpermute_b32 v26, v18, v20
    ds_bpermute_b32 v27, v19, v20
    ds_bpermute_b32 v28, v16, v21
    ds_bpermute_b32 v29, v17, v21
    ds_bpermute_b32 v30, v18, v21
    ds_bpermute_b32 v31, v19, v21
    v_mfma_f32_16x16x32_bf16 v[192:195], v[96:99], a[128:131], v[192:195]
    v_mfma_f32_16x16x32_bf16 v[192:195], v[100:103], a[132:135], v[192:195]
    v_mfma_f32_16x16x32_bf16 v[196:199], v[100:103], a[140:143], v[196:199]
    v_mfma_f32_16x16x32_bf16 v[196:199], v[96:99], a[136:139], v[196:199]
    v_mfma_f32_16x16x32_bf16 v[200:203], v[96:99], a[144:147], v[200:203]
    v_mfma_f32_16x16x32_bf16 v[200:203], v[100:103], a[148:151], v[200:203]
    v_mfma_f32_16x16x32_bf16 v[204:207], v[100:103], a[156:159], v[204:207]
    v_mfma_f32_16x16x32_bf16 v[204:207], v[96:99], a[152:155], v[204:207]
    s_waitcnt lgkmcnt(0)
    v_mul_f32 v56, s99, v24
    v_mul_f32 v57, s99, v25
    v_pk_fma_f32 v[128:129], v[128:129], v[24:25], v[56:57] neg_lo:[0,0,1] neg_hi:[0,0,1]
    v_pk_fma_f32 v[132:133], v[132:133], v[24:25], v[56:57] neg_lo:[0,0,1] neg_hi:[0,0,1]
    v_pk_fma_f32 v[136:137], v[136:137], v[24:25], v[56:57] neg_lo:[0,0,1] neg_hi:[0,0,1]
    v_pk_fma_f32 v[140:141], v[140:141], v[24:25], v[56:57] neg_lo:[0,0,1] neg_hi:[0,0,1]
    v_pk_fma_f32 v[144:145], v[144:145], v[24:25], v[56:57] neg_lo:[0,0,1] neg_hi:[0,0,1]
    v_pk_fma_f32 v[148:149], v[148:149], v[24:25], v[56:57] neg_lo:[0,0,1] neg_hi:[0,0,1]
    v_pk_fma_f32 v[152:153], v[152:153], v[24:25], v[56:57] neg_lo:[0,0,1] neg_hi:[0,0,1]
    v_pk_fma_f32 v[156:157], v[156:157], v[24:25], v[56:57] neg_lo:[0,0,1] neg_hi:[0,0,1]
    v_cvt_pk_bf16_f32 v64, v128, v132
    v_cvt_pk_bf16_f32 v65, v136, v140
    v_cvt_pk_bf16_f32 v66, v144, v148
    v_cvt_pk_bf16_f32 v67, v152, v156
    buffer_store_dwordx4 v[64:67], v4, s[16:19], s31 offen offset:0 sc0 sc1
    v_cvt_pk_bf16_f32 v68, v129, v133
    v_cvt_pk_bf16_f32 v69, v137, v141
    v_cvt_pk_bf16_f32 v70, v145, v149
    v_cvt_pk_bf16_f32 v71, v153, v157
    buffer_store_dwordx4 v[68:71], v4, s[16:19], s31 offen offset:256 sc0 sc1
    v_mul_f32 v56, s99, v26
    v_mul_f32 v57, s99, v27
    v_pk_fma_f32 v[130:131], v[130:131], v[26:27], v[56:57] neg_lo:[0,0,1] neg_hi:[0,0,1]
    v_pk_fma_f32 v[134:135], v[134:135], v[26:27], v[56:57] neg_lo:[0,0,1] neg_hi:[0,0,1]
    v_pk_fma_f32 v[138:139], v[138:139], v[26:27], v[56:57] neg_lo:[0,0,1] neg_hi:[0,0,1]
    v_pk_fma_f32 v[142:143], v[142:143], v[26:27], v[56:57] neg_lo:[0,0,1] neg_hi:[0,0,1]
    v_pk_fma_f32 v[146:147], v[146:147], v[26:27], v[56:57] neg_lo:[0,0,1] neg_hi:[0,0,1]
    v_pk_fma_f32 v[150:151], v[150:151], v[26:27], v[56:57] neg_lo:[0,0,1] neg_hi:[0,0,1]
    v_pk_fma_f32 v[154:155], v[154:155], v[26:27], v[56:57] neg_lo:[0,0,1] neg_hi:[0,0,1]
    v_pk_fma_f32 v[158:159], v[158:159], v[26:27], v[56:57] neg_lo:[0,0,1] neg_hi:[0,0,1]
    v_cvt_pk_bf16_f32 v72, v130, v134
    v_cvt_pk_bf16_f32 v73, v138, v142
    v_cvt_pk_bf16_f32 v74, v146, v150
    v_cvt_pk_bf16_f32 v75, v154, v158
    buffer_store_dwordx4 v[72:75], v4, s[16:19], s31 offen offset:512 sc0 sc1
    v_cvt_pk_bf16_f32 v76, v131, v135
    v_cvt_pk_bf16_f32 v77, v139, v143
    v_cvt_pk_bf16_f32 v78, v147, v151
    v_cvt_pk_bf16_f32 v79, v155, v159
    buffer_store_dwordx4 v[76:79], v4, s[16:19], s31 offen offset:768 sc0 sc1
    v_mfma_f32_16x16x32_bf16 v[236:239], v[112:115], a[152:155], v[236:239]
    v_mfma_f32_16x16x32_bf16 v[236:239], v[116:119], a[156:159], v[236:239]
    v_mfma_f32_16x16x32_bf16 v[232:235], v[116:119], a[148:151], v[232:235]
    v_mfma_f32_16x16x32_bf16 v[232:235], v[112:115], a[144:147], v[232:235]
    v_mfma_f32_16x16x32_bf16 v[228:231], v[112:115], a[136:139], v[228:231]
    v_mfma_f32_16x16x32_bf16 v[228:231], v[116:119], a[140:143], v[228:231]
    v_mfma_f32_16x16x32_bf16 v[224:227], v[116:119], a[132:135], v[224:227]
    v_mfma_f32_16x16x32_bf16 v[224:227], v[112:115], a[128:131], v[224:227]
    v_mfma_f32_16x16x32_bf16 v[240:243], v[112:115], a[160:163], v[240:243]
    v_mfma_f32_16x16x32_bf16 v[240:243], v[116:119], a[164:167], v[240:243]
    v_mfma_f32_16x16x32_bf16 v[244:247], v[116:119], a[172:175], v[244:247]
    v_mfma_f32_16x16x32_bf16 v[244:247], v[112:115], a[168:171], v[244:247]
    v_add_f32 v14, v52, v53
    v_add_f32 v15, v54, v55
    v_rcp_f32 v22, v14
    v_rcp_f32 v23, v15
    s_mov_b32 s30, 0x43800000
    v_add_f32 v12, v12, v13
    v_add_f32 v14, v14, v15
    v_add_f32 v12, v12, v14
    v_cmp_nlt_f32 vcc, v12, s30
    ds_bpermute_b32 v24, v16, v22
    ds_bpermute_b32 v25, v17, v22
    ds_bpermute_b32 v26, v18, v22
    ds_bpermute_b32 v27, v19, v22
    v_mfma_f32_16x16x32_bf16 v[248:251], v[112:115], a[176:179], v[248:251]
    v_mfma_f32_16x16x32_bf16 v[248:251], v[116:119], a[180:183], v[248:251]
    v_mfma_f32_16x16x32_bf16 v[252:255], v[116:119], a[188:191], v[252:255]
    v_mfma_f32_16x16x32_bf16 v[252:255], v[112:115], a[184:187], v[252:255]
    v_mfma_f32_16x16x32_bf16 v[220:223], v[96:99], a[184:187], v[220:223]
    v_mfma_f32_16x16x32_bf16 v[220:223], v[100:103], a[188:191], v[220:223]
    v_mfma_f32_16x16x32_bf16 v[216:219], v[100:103], a[180:183], v[216:219]
    v_mfma_f32_16x16x32_bf16 v[216:219], v[96:99], a[176:179], v[216:219]
    v_mfma_f32_16x16x32_bf16 v[212:215], v[96:99], a[168:171], v[212:215]
    v_mfma_f32_16x16x32_bf16 v[212:215], v[100:103], a[172:175], v[212:215]
    v_mfma_f32_16x16x32_bf16 v[208:211], v[100:103], a[164:167], v[208:211]
    v_mfma_f32_16x16x32_bf16 v[208:211], v[96:99], a[160:163], v[208:211]
    v_mul_f32 v56, s99, v28
    v_mul_f32 v57, s99, v29
    v_pk_fma_f32 v[160:161], v[160:161], v[28:29], v[56:57] neg_lo:[0,0,1] neg_hi:[0,0,1]
    v_pk_fma_f32 v[164:165], v[164:165], v[28:29], v[56:57] neg_lo:[0,0,1] neg_hi:[0,0,1]
    v_pk_fma_f32 v[168:169], v[168:169], v[28:29], v[56:57] neg_lo:[0,0,1] neg_hi:[0,0,1]
    v_pk_fma_f32 v[172:173], v[172:173], v[28:29], v[56:57] neg_lo:[0,0,1] neg_hi:[0,0,1]
    v_pk_fma_f32 v[176:177], v[176:177], v[28:29], v[56:57] neg_lo:[0,0,1] neg_hi:[0,0,1]
    v_pk_fma_f32 v[180:181], v[180:181], v[28:29], v[56:57] neg_lo:[0,0,1] neg_hi:[0,0,1]
    v_pk_fma_f32 v[184:185], v[184:185], v[28:29], v[56:57] neg_lo:[0,0,1] neg_hi:[0,0,1]
    v_pk_fma_f32 v[188:189], v[188:189], v[28:29], v[56:57] neg_lo:[0,0,1] neg_hi:[0,0,1]
    v_cvt_pk_bf16_f32 v80, v160, v164
    v_cvt_pk_bf16_f32 v81, v168, v172
    v_cvt_pk_bf16_f32 v82, v176, v180
    v_cvt_pk_bf16_f32 v83, v184, v188
    buffer_store_dwordx4 v[80:83], v4, s[16:19], s32 offen offset:0 sc0 sc1
    v_cvt_pk_bf16_f32 v84, v161, v165
    v_cvt_pk_bf16_f32 v85, v169, v173
    v_cvt_pk_bf16_f32 v86, v177, v181
    v_cvt_pk_bf16_f32 v87, v185, v189
    buffer_store_dwordx4 v[84:87], v4, s[16:19], s32 offen offset:256 sc0 sc1
    v_mul_f32 v56, s99, v30
    v_mul_f32 v57, s99, v31
    v_pk_fma_f32 v[162:163], v[162:163], v[30:31], v[56:57] neg_lo:[0,0,1] neg_hi:[0,0,1]
    v_pk_fma_f32 v[166:167], v[166:167], v[30:31], v[56:57] neg_lo:[0,0,1] neg_hi:[0,0,1]
    v_pk_fma_f32 v[170:171], v[170:171], v[30:31], v[56:57] neg_lo:[0,0,1] neg_hi:[0,0,1]
    v_pk_fma_f32 v[174:175], v[174:175], v[30:31], v[56:57] neg_lo:[0,0,1] neg_hi:[0,0,1]
    v_pk_fma_f32 v[178:179], v[178:179], v[30:31], v[56:57] neg_lo:[0,0,1] neg_hi:[0,0,1]
    v_pk_fma_f32 v[182:183], v[182:183], v[30:31], v[56:57] neg_lo:[0,0,1] neg_hi:[0,0,1]
    v_pk_fma_f32 v[186:187], v[186:187], v[30:31], v[56:57] neg_lo:[0,0,1] neg_hi:[0,0,1]
    v_pk_fma_f32 v[190:191], v[190:191], v[30:31], v[56:57] neg_lo:[0,0,1] neg_hi:[0,0,1]
    v_cvt_pk_bf16_f32 v88, v162, v166
    v_cvt_pk_bf16_f32 v89, v170, v174
    v_cvt_pk_bf16_f32 v90, v178, v182
    v_cvt_pk_bf16_f32 v91, v186, v190
    buffer_store_dwordx4 v[88:91], v4, s[16:19], s32 offen offset:512 sc0 sc1
    v_cvt_pk_bf16_f32 v92, v163, v167
    v_cvt_pk_bf16_f32 v93, v171, v175
    v_cvt_pk_bf16_f32 v94, v179, v183
    v_cvt_pk_bf16_f32 v95, v187, v191
    buffer_store_dwordx4 v[92:95], v4, s[16:19], s32 offen offset:768 sc0 sc1
    s_cbranch_vccnz L_slow
    ds_bpermute_b32 v28, v16, v23
    ds_bpermute_b32 v29, v17, v23
    ds_bpermute_b32 v30, v18, v23
    ds_bpermute_b32 v31, v19, v23
    s_waitcnt lgkmcnt(4)
    v_mul_f32 v56, s99, v24
    v_mul_f32 v57, s99, v25
    v_pk_fma_f32 v[192:193], v[192:193], v[24:25], v[56:57] neg_lo:[0,0,1] neg_hi:[0,0,1]
    v_pk_fma_f32 v[196:197], v[196:197], v[24:25], v[56:57] neg_lo:[0,0,1] neg_hi:[0,0,1]
    v_pk_fma_f32 v[200:201], v[200:201], v[24:25], v[56:57] neg_lo:[0,0,1] neg_hi:[0,0,1]
    v_pk_fma_f32 v[204:205], v[204:205], v[24:25], v[56:57] neg_lo:[0,0,1] neg_hi:[0,0,1]
    v_pk_fma_f32 v[208:209], v[208:209], v[24:25], v[56:57] neg_lo:[0,0,1] neg_hi:[0,0,1]
    v_pk_fma_f32 v[212:213], v[212:213], v[24:25], v[56:57] neg_lo:[0,0,1] neg_hi:[0,0,1]
    v_pk_fma_f32 v[216:217], v[216:217], v[24:25], v[56:57] neg_lo:[0,0,1] neg_hi:[0,0,1]
    v_pk_fma_f32 v[220:221], v[220:221], v[24:25], v[56:57] neg_lo:[0,0,1] neg_hi:[0,0,1]
    v_cvt_pk_bf16_f32 v96, v192, v196
    v_cvt_pk_bf16_f32 v97, v200, v204
    v_cvt_pk_bf16_f32 v98, v208, v212
    v_cvt_pk_bf16_f32 v99, v216, v220
    buffer_store_dwordx4 v[96:99], v4, s[16:19], s33 offen offset:0 sc0 sc1
    v_cvt_pk_bf16_f32 v100, v193, v197
    v_cvt_pk_bf16_f32 v101, v201, v205
    v_cvt_pk_bf16_f32 v102, v209, v213
    v_cvt_pk_bf16_f32 v103, v217, v221
    buffer_store_dwordx4 v[100:103], v4, s[16:19], s33 offen offset:256 sc0 sc1
    v_mul_f32 v56, s99, v26
    v_mul_f32 v57, s99, v27
    v_pk_fma_f32 v[194:195], v[194:195], v[26:27], v[56:57] neg_lo:[0,0,1] neg_hi:[0,0,1]
    v_pk_fma_f32 v[198:199], v[198:199], v[26:27], v[56:57] neg_lo:[0,0,1] neg_hi:[0,0,1]
    v_pk_fma_f32 v[202:203], v[202:203], v[26:27], v[56:57] neg_lo:[0,0,1] neg_hi:[0,0,1]
    v_pk_fma_f32 v[206:207], v[206:207], v[26:27], v[56:57] neg_lo:[0,0,1] neg_hi:[0,0,1]
    v_pk_fma_f32 v[210:211], v[210:211], v[26:27], v[56:57] neg_lo:[0,0,1] neg_hi:[0,0,1]
    v_pk_fma_f32 v[214:215], v[214:215], v[26:27], v[56:57] neg_lo:[0,0,1] neg_hi:[0,0,1]
    v_pk_fma_f32 v[218:219], v[218:219], v[26:27], v[56:57] neg_lo:[0,0,1] neg_hi:[0,0,1]
    v_pk_fma_f32 v[222:223], v[222:223], v[26:27], v[56:57] neg_lo:[0,0,1] neg_hi:[0,0,1]
    v_cvt_pk_bf16_f32 v104, v194, v198
    v_cvt_pk_bf16_f32 v105, v202, v206
    v_cvt_pk_bf16_f32 v106, v210, v214
    v_cvt_pk_bf16_f32 v107, v218, v222
    buffer_store_dwordx4 v[104:107], v4, s[16:19], s33 offen offset:512 sc0 sc1
    v_cvt_pk_bf16_f32 v108, v195, v199
    v_cvt_pk_bf16_f32 v109, v203, v207
    v_cvt_pk_bf16_f32 v110, v211, v215
    v_cvt_pk_bf16_f32 v111, v219, v223
    buffer_store_dwordx4 v[108:111], v4, s[16:19], s33 offen offset:768 sc0 sc1
    s_waitcnt lgkmcnt(0)
    v_mul_f32 v56, s99, v28
    v_mul_f32 v57, s99, v29
    v_pk_fma_f32 v[224:225], v[224:225], v[28:29], v[56:57] neg_lo:[0,0,1] neg_hi:[0,0,1]
    v_pk_fma_f32 v[228:229], v[228:229], v[28:29], v[56:57] neg_lo:[0,0,1] neg_hi:[0,0,1]
    v_pk_fma_f32 v[232:233], v[232:233], v[28:29], v[56:57] neg_lo:[0,0,1] neg_hi:[0,0,1]
    v_pk_fma_f32 v[236:237], v[236:237], v[28:29], v[56:57] neg_lo:[0,0,1] neg_hi:[0,0,1]
    v_pk_fma_f32 v[240:241], v[240:241], v[28:29], v[56:57] neg_lo:[0,0,1] neg_hi:[0,0,1]
    v_pk_fma_f32 v[244:245], v[244:245], v[28:29], v[56:57] neg_lo:[0,0,1] neg_hi:[0,0,1]
    v_pk_fma_f32 v[248:249], v[248:249], v[28:29], v[56:57] neg_lo:[0,0,1] neg_hi:[0,0,1]
    v_pk_fma_f32 v[252:253], v[252:253], v[28:29], v[56:57] neg_lo:[0,0,1] neg_hi:[0,0,1]
    v_cvt_pk_bf16_f32 v112, v224, v228
    v_cvt_pk_bf16_f32 v113, v232, v236
    v_cvt_pk_bf16_f32 v114, v240, v244
    v_cvt_pk_bf16_f32 v115, v248, v252
    buffer_store_dwordx4 v[112:115], v4, s[16:19], s34 offen offset:0 sc0 sc1
    v_cvt_pk_bf16_f32 v116, v225, v229
    v_cvt_pk_bf16_f32 v117, v233, v237
    v_cvt_pk_bf16_f32 v118, v241, v245
    v_cvt_pk_bf16_f32 v119, v249, v253
    buffer_store_dwordx4 v[116:119], v4, s[16:19], s34 offen offset:256 sc0 sc1
    v_mul_f32 v56, s99, v30
    v_mul_f32 v57, s99, v31
    v_pk_fma_f32 v[226:227], v[226:227], v[30:31], v[56:57] neg_lo:[0,0,1] neg_hi:[0,0,1]
    v_pk_fma_f32 v[230:231], v[230:231], v[30:31], v[56:57] neg_lo:[0,0,1] neg_hi:[0,0,1]
    v_pk_fma_f32 v[234:235], v[234:235], v[30:31], v[56:57] neg_lo:[0,0,1] neg_hi:[0,0,1]
    v_pk_fma_f32 v[238:239], v[238:239], v[30:31], v[56:57] neg_lo:[0,0,1] neg_hi:[0,0,1]
    v_pk_fma_f32 v[242:243], v[242:243], v[30:31], v[56:57] neg_lo:[0,0,1] neg_hi:[0,0,1]
    v_pk_fma_f32 v[246:247], v[246:247], v[30:31], v[56:57] neg_lo:[0,0,1] neg_hi:[0,0,1]
    v_pk_fma_f32 v[250:251], v[250:251], v[30:31], v[56:57] neg_lo:[0,0,1] neg_hi:[0,0,1]
    v_pk_fma_f32 v[254:255], v[254:255], v[30:31], v[56:57] neg_lo:[0,0,1] neg_hi:[0,0,1]
    v_cvt_pk_bf16_f32 v120, v226, v230
    v_cvt_pk_bf16_f32 v121, v234, v238
    v_cvt_pk_bf16_f32 v122, v242, v246
    v_cvt_pk_bf16_f32 v123, v250, v254
    buffer_store_dwordx4 v[120:123], v4, s[16:19], s34 offen offset:512 sc0 sc1
    v_cvt_pk_bf16_f32 v124, v227, v231
    v_cvt_pk_bf16_f32 v125, v235, v239
    v_cvt_pk_bf16_f32 v126, v243, v247
    v_cvt_pk_bf16_f32 v127, v251, v255
    buffer_store_dwordx4 v[124:127], v4, s[16:19], s34 offen offset:768 sc0 sc1
L_end:
    s_endpgm
L_spin:
    ds_read_b32 v9, v8
    s_waitcnt lgkmcnt(0)
    v_cmp_gt_u32 vcc, v7, v9
    s_cbranch_vccnz L_spin
    s_branch L_spin_ret
L_poll:
    s_mov_b32 s21, 0
    s_mov_b32 s68, s60
    s_or_b32 s69, s61, 0xf0000000
L_poll_l:
    s_add_u32 s3, s100, 0x2000
    buffer_load_dwordx4 v[56:59], v1, s[4:7], s100 offen sc1
    buffer_load_dwordx4 v[60:63], v1, s[4:7], s3 offen sc1
    s_waitcnt vmcnt(0)
    v_subrev_co_u32 v56, vcc, s60, v56
    v_mov_b32 v15, s61
    s_nop 0
    v_subb_co_u32 v57, vcc, v57, v15, vcc
    v_lshrrev_b32 v56, 24, v56
    v_or_b32 v56, v56, v57
    v_subrev_co_u32 v58, vcc, s60, v58
    v_mov_b32 v15, s61
    s_nop 0
    v_subb_co_u32 v59, vcc, v59, v15, vcc
    v_lshrrev_b32 v58, 24, v58
    v_or_b32 v58, v58, v59
    v_subrev_co_u32 v60, vcc, s68, v60
    v_mov_b32 v15, s69
    s_nop 0
    v_subb_co_u32 v61, vcc, v61, v15, vcc
    v_lshrrev_b32 v60, 24, v60
    v_or_b32 v60, v60, v61
    v_subrev_co_u32 v62, vcc, s68, v62
    v_mov_b32 v15, s69
    s_nop 0
    v_subb_co_u32 v63, vcc, v63, v15, vcc
    v_lshrrev_b32 v62, 24, v62
    v_or_b32 v62, v62, v63
    v_min_u32 v56, v56, v60
    v_min_u32 v58, v58, v62
    v_min_u32 v60, v60, v62
    v_or_b32 v56, v56, v58
    v_cmp_ne_u32 vcc, 0, v56
    v_cmp_eq_u32 s[96:97], 0, v60
    s_or_b32 s3, s42, s24
    s_cselect_b64 s[96:97], 0, s[96:97]
    s_cmp_lg_u64 s[96:97], 0
    s_cbranch_scc1 L_poll_t
    s_cmp_lg_u64 vcc, 0
    s_cbranch_scc0 L_poll_e
    s_add_u32 s21, s21, 1
    s_cmp_lg_u32 s3, 0
    s_cbranch_scc1 L_poll_w
    s_cmp_lt_u32 s21, 12
    s_cbranch_scc1 L_poll_w
L_poll_t:
    s_mov_b32 s42, 1
    s_mov_b64 s[96:97], s[64:65]
    s_bitcmp1_b32 s20, 0
    s_cbranch_scc1 L_poll_f
    s_call_b64 s[66:67], L_early
    s_mov_b32 s68, s60
    s_or_b32 s69, s61, 0xf0000000
    s_waitcnt vmcnt(0)
L_poll_f:
    s_call_b64 s[64:65], L_flag
    s_mov_b64 s[64:65], s[96:97]
L_poll_w:
    s_sleep 1
    s_cmp_lt_u32 s21, s25
    s_cbranch_scc1 L_poll_l
    s_cmp_eq_u32 s21, s21
L_poll_e:
    s_setpc_b64 s[64:65]
L_redo:
    s_mov_b32 s43, 1
    s_mov_b32 s21, 0
L_redo_l:
    s_and_b32 s23, s21, 3
    s_lshr_b32 s22, s21, 2
    s_and_b32 s22, s22, 63
    s_lshr_b32 s41, s21, 8
    s_call_b64 s[64:65], L_usetup
    s_call_b64 s[64:65], L_uload
    s_waitcnt vmcnt(0)
    s_call_b64 s[64:65], L_uproc
    s_add_u32 s21, s21, 1
    s_cmp_lt_u32 s21, 512
    s_cbranch_scc1 L_redo_l
    s_lshr_b32 s41, s20, 1
    s_and_b32 s22, s20, 1
    s_lshl_b32 s22, s22, 3
    s_lshr_b32 s3, s29, 2
    s_add_u32 s22, s22, s3
    s_add_u32 s22, s22, 16
    s_and_b32 s23, s29, 3
    s_call_b64 s[64:65], L_usetup
    s_waitcnt vmcnt(0)
    s_branch L_go
L_slow:
    s_mov_b32 s99, 0
    s_waitcnt vmcnt(0) lgkmcnt(0)
    v_mov_b32 v16, 0xff800000
    v_mov_b32 v17, 0xff800000
    v_mov_b32 v18, 0xff800000
    v_mov_b32 v19, 0xff800000
    s_mov_b32 s36, 0
L_slow1:
    s_add_u32 s37, s36, 0
    s_add_u32 s38, s37, 4096
    s_add_u32 s39, s37, 8192
    s_add_u32 s40, s37, 12288
    buffer_load_dwordx4 a[64:67], v1, s[12:15], s37 offen offset:0 sc1
    buffer_load_dwordx4 a[68:71], v1, s[12:15], s37 offen offset:1024 sc1
    buffer_load_dwordx4 a[72:75], v1, s[12:15], s37 offen offset:2048 sc1
    buffer_load_dwordx4 a[76:79], v1, s[12:15], s37 offen offset:3072 sc1
    buffer_load_dwordx4 a[80:83], v1, s[12:15], s38 offen offset:0 sc1
    buffer_load_dwordx4 a[84:87], v1, s[12:15], s38 offen offset:1024 sc1
    buffer_load_dwordx4 a[88:91], v1, s[12:15], s38 offen offset:2048 sc1
    buffer_load_dwordx4 a[92:95], v1, s[12:15], s38 offen offset:3072 sc1
    s_add_u32 s37, s36, 16384
    s_add_u32 s38, s37, 4096
    s_add_u32 s39, s37, 8192
    s_add_u32 s40, s37, 12288
    buffer_load_dwordx4 a[96:99], v1, s[12:15], s37 offen offset:0 sc1
    buffer_load_dwordx4 a[100:103], v1, s[12:15], s37 offen offset:1024 sc1
    buffer_load_dwordx4 a[104:107], v1, s[12:15], s37 offen offset:2048 sc1
    buffer_load_dwordx4 a[108:111], v1, s[12:15], s37 offen offset:3072 sc1
    buffer_load_dwordx4 a[112:115], v1, s[12:15], s38 offen offset:0 sc1
    buffer_load_dwordx4 a[116:119], v1, s[12:15], s38 offen offset:1024 sc1
    buffer_load_dwordx4 a[120:123], v1, s[12:15], s38 offen offset:2048 sc1
    buffer_load_dwordx4 a[124:127], v1, s[12:15], s38 offen offset:3072 sc1
    s_waitcnt vmcnt(0)
    v_mfma_f32_16x16x32_bf16 v[64:67], a[64:67], a[0:3], 0
    v_mfma_f32_16x16x32_bf16 v[64:67], a[68:71], a[4:7], v[64:67]
    v_mfma_f32_16x16x32_bf16 v[64:67], a[72:75], a[8:11], v[64:67]
    v_mfma_f32_16x16x32_bf16 v[64:67], a[76:79], a[12:15], v[64:67]
    v_mfma_f32_16x16x32_bf16 v[68:71], a[92:95], a[12:15], 0
    v_mfma_f32_16x16x32_bf16 v[68:71], a[88:91], a[8:11], v[68:71]
    v_mfma_f32_16x16x32_bf16 v[68:71], a[84:87], a[4:7], v[68:71]
    v_mfma_f32_16x16x32_bf16 v[68:71], a[80:83], a[0:3], v[68:71]
    v_mfma_f32_16x16x32_bf16 v[84:87], a[80:83], a[16:19], 0
    v_mfma_f32_16x16x32_bf16 v[84:87], a[84:87], a[20:23], v[84:87]
    v_mfma_f32_16x16x32_bf16 v[84:87], a[88:91], a[24:27], v[84:87]
    v_mfma_f32_16x16x32_bf16 v[84:87], a[92:95], a[28:31], v[84:87]
    v_mfma_f32_16x16x32_bf16 v[80:83], a[76:79], a[28:31], 0
    v_mfma_f32_16x16x32_bf16 v[80:83], a[72:75], a[24:27], v[80:83]
    v_mfma_f32_16x16x32_bf16 v[80:83], a[68:71], a[20:23], v[80:83]
    v_mfma_f32_16x16x32_bf16 v[80:83], a[64:67], a[16:19], v[80:83]
    v_mfma_f32_16x16x32_bf16 v[88:91], a[96:99], a[16:19], 0
    v_mfma_f32_16x16x32_bf16 v[88:91], a[100:103], a[20:23], v[88:91]
    v_mfma_f32_16x16x32_bf16 v[88:91], a[104:107], a[24:27], v[88:91]
    v_mfma_f32_16x16x32_bf16 v[88:91], a[108:111], a[28:31], v[88:91]
    v_mfma_f32_16x16x32_bf16 v[92:95], a[124:127], a[28:31], 0
    v_mfma_f32_16x16x32_bf16 v[92:95], a[120:123], a[24:27], v[92:95]
    v_mfma_f32_16x16x32_bf16 v[92:95], a[116:119], a[20:23], v[92:95]
    v_mfma_f32_16x16x32_bf16 v[92:95], a[112:115], a[16:19], v[92:95]
    v_mfma_f32_16x16x32_bf16 v[76:79], a[112:115], a[0:3], 0
    v_mfma_f32_16x16x32_bf16 v[76:79], a[116:119], a[4:7], v[76:79]
    v_mfma_f32_16x16x32_bf16 v[76:79], a[120:123], a[8:11], v[76:79]
    v_mfma_f32_16x16x32_bf16 v[76:79], a[124:127], a[12:15], v[76:79]
    v_mfma_f32_16x16x32_bf16 v[72:75], a[108:111], a[12:15], 0
    v_mfma_f32_16x16x32_bf16 v[72:75], a[104:107], a[8:11], v[72:75]
    v_mfma_f32_16x16x32_bf16 v[72:75], a[100:103], a[4:7], v[72:75]
    v_mfma_f32_16x16x32_bf16 v[72:75], a[96:99], a[0:3], v[72:75]
    v_mfma_f32_16x16x32_bf16 v[96:99], a[64:67], a[32:35], 0
    v_mfma_f32_16x16x32_bf16 v[96:99], a[68:71], a[36:39], v[96:99]
    v_mfma_f32_16x16x32_bf16 v[96:99], a[72:75], a[40:43], v[96:99]
    v_mfma_f32_16x16x32_bf16 v[96:99], a[76:79], a[44:47], v[96:99]
    v_mfma_f32_16x16x32_bf16 v[100:103], a[92:95], a[44:47], 0
    v_mfma_f32_16x16x32_bf16 v[100:103], a[88:91], a[40:43], v[100:103]
    v_mfma_f32_16x16x32_bf16 v[100:103], a[84:87], a[36:39], v[100:103]
    v_mfma_f32_16x16x32_bf16 v[100:103], a[80:83], a[32:35], v[100:103]
    v_mfma_f32_16x16x32_bf16 v[116:119], a[80:83], a[48:51], 0
    v_mfma_f32_16x16x32_bf16 v[116:119], a[84:87], a[52:55], v[116:119]
    v_mfma_f32_16x16x32_bf16 v[116:119], a[88:91], a[56:59], v[116:119]
    v_mfma_f32_16x16x32_bf16 v[116:119], a[92:95], a[60:63], v[116:119]
    v_mfma_f32_16x16x32_bf16 v[112:115], a[76:79], a[60:63], 0
    v_mfma_f32_16x16x32_bf16 v[112:115], a[72:75], a[56:59], v[112:115]
    v_mfma_f32_16x16x32_bf16 v[112:115], a[68:71], a[52:55], v[112:115]
    v_mfma_f32_16x16x32_bf16 v[112:115], a[64:67], a[48:51], v[112:115]
    v_mfma_f32_16x16x32_bf16 v[120:123], a[96:99], a[48:51], 0
    v_mfma_f32_16x16x32_bf16 v[120:123], a[100:103], a[52:55], v[120:123]
    v_mfma_f32_16x16x32_bf16 v[120:123], a[104:107], a[56:59], v[120:123]
    v_mfma_f32_16x16x32_bf16 v[120:123], a[108:111], a[60:63], v[120:123]
    v_mfma_f32_16x16x32_bf16 v[124:127], a[124:127], a[60:63], 0
    v_mfma_f32_16x16x32_bf16 v[124:127], a[120:123], a[56:59], v[124:127]
    v_mfma_f32_16x16x32_bf16 v[124:127], a[116:119], a[52:55], v[124:127]
    v_mfma_f32_16x16x32_bf16 v[124:127], a[112:115], a[48:51], v[124:127]
    v_mfma_f32_16x16x32_bf16 v[108:111], a[112:115], a[32:35], 0
    v_mfma_f32_16x16x32_bf16 v[108:111], a[116:119], a[36:39], v[108:111]
    v_mfma_f32_16x16x32_bf16 v[108:111], a[120:123], a[40:43], v[108:111]
    v_mfma_f32_16x16x32_bf16 v[108:111], a[124:127], a[44:47], v[108:111]
    v_mfma_f32_16x16x32_bf16 v[104:107], a[108:111], a[44:47], 0
    v_mfma_f32_16x16x32_bf16 v[104:107], a[104:107], a[40:43], v[104:107]
    v_mfma_f32_16x16x32_bf16 v[104:107], a[100:103], a[36:39], v[104:107]
    v_mfma_f32_16x16x32_bf16 v[104:107], a[96:99], a[32:35], v[104:107]
    s_nop 7
    v_max3_f32 v16, v16, v64, v65
    v_max3_f32 v16, v16, v66, v67
    v_max3_f32 v16, v16, v68, v69
    v_max3_f32 v16, v16, v70, v71
    v_max3_f32 v16, v16, v72, v73
    v_max3_f32 v16, v16, v74, v75
    v_max3_f32 v16, v16, v76, v77
    v_max3_f32 v16, v16, v78, v79
    v_max3_f32 v17, v17, v80, v81
    v_max3_f32 v17, v17, v82, v83
    v_max3_f32 v17, v17, v84, v85
    v_max3_f32 v17, v17, v86, v87
    v_max3_f32 v17, v17, v88, v89
    v_max3_f32 v17, v17, v90, v91
    v_max3_f32 v17, v17, v92, v93
    v_max3_f32 v17, v17, v94, v95
    v_max3_f32 v18, v18, v96, v97
    v_max3_f32 v18, v18, v98, v99
    v_max3_f32 v18, v18, v100, v101
    v_max3_f32 v18, v18, v102, v103
    v_max3_f32 v18, v18, v104, v105
    v_max3_f32 v18, v18, v106, v107
    v_max3_f32 v18, v18, v108, v109
    v_max3_f32 v18, v18, v110, v111
    v_max3_f32 v19, v19, v112, v113
    v_max3_f32 v19, v19, v114, v115
    v_max3_f32 v19, v19, v116, v117
    v_max3_f32 v19, v19, v118, v119
    v_max3_f32 v19, v19, v120, v121
    v_max3_f32 v19, v19, v122, v123
    v_max3_f32 v19, v19, v124, v125
    v_max3_f32 v19, v19, v126, v127
    s_add_u32 s36, s36, 0x8000
    s_cmp_lt_u32 s36, 0x100000
    s_cbranch_scc1 L_slow1
    v_mov_b32 v24, v16
    v_mov_b32 v25, v17
    v_mov_b32 v26, v18
    v_mov_b32 v27, v19
    v_permlane32_swap_b32 v16, v24
    v_permlane32_swap_b32 v17, v25
    v_permlane32_swap_b32 v18, v26
    v_permlane32_swap_b32 v19, v27
    v_max_f32 v16, v16, v24
    v_max_f32 v17, v17, v25
    v_max_f32 v18, v18, v26
    v_max_f32 v19, v19, v27
    v_mov_b32 v24, v16
    v_mov_b32 v25, v17
    v_mov_b32 v26, v18
    v_mov_b32 v27, v19
    v_permlane16_swap_b32 v16, v24
    v_permlane16_swap_b32 v17, v25
    v_permlane16_swap_b32 v18, v26
    v_permlane16_swap_b32 v19, v27
    v_max_f32 v16, v16, v24
    v_max_f32 v17, v17, v25
    v_max_f32 v18, v18, v26
    v_max_f32 v19, v19, v27
    v_sub_f32 v32, s98, v16
    v_sub_f32 v33, s98, v16
    v_sub_f32 v34, s98, v16
    v_sub_f32 v35, s98, v16
    v_sub_f32 v36, s98, v17
    v_sub_f32 v37, s98, v17
    v_sub_f32 v38, s98, v17
    v_sub_f32 v39, s98, v17
    v_sub_f32 v40, s98, v18
    v_sub_f32 v41, s98, v18
    v_sub_f32 v42, s98, v18
    v_sub_f32 v43, s98, v18
    v_sub_f32 v44, s98, v19
    v_sub_f32 v45, s98, v19
    v_sub_f32 v46, s98, v19
    v_sub_f32 v47, s98, v19
    v_mov_b32 v128, 0
    v_mov_b32 v129, 0
    v_mov_b32 v130, 0
    v_mov_b32 v131, 0
    v_mov_b32 v132, 0
    v_mov_b32 v133, 0
    v_mov_b32 v134, 0
    v_mov_b32 v135, 0
    v_mov_b32 v136, 0
    v_mov_b32 v137, 0
    v_mov_b32 v138, 0
    v_mov_b32 v139, 0
    v_mov_b32 v140, 0
    v_mov_b32 v141, 0
    v_mov_b32 v142, 0
    v_mov_b32 v143, 0
    v_mov_b32 v144, 0
    v_mov_b32 v145, 0
    v_mov_b32 v146, 0
    v_mov_b32 v147, 0
    v_mov_b32 v148, 0
    v_mov_b32 v149, 0
    v_mov_b32 v150, 0
    v_mov_b32 v151, 0
    v_mov_b32 v152, 0
    v_mov_b32 v153, 0
    v_mov_b32 v154, 0
    v_mov_b32 v155, 0
    v_mov_b32 v156, 0
    v_mov_b32 v157, 0
    v_mov_b32 v158, 0
    v_mov_b32 v159, 0
    v_mov_b32 v160, 0
    v_mov_b32 v161, 0
    v_mov_b32 v162, 0
    v_mov_b32 v163, 0
    v_mov_b32 v164, 0
    v_mov_b32 v165, 0
    v_mov_b32 v166, 0
    v_mov_b32 v167, 0
    v_mov_b32 v168, 0
    v_mov_b32 v169, 0
    v_mov_b32 v170, 0
    v_mov_b32 v171, 0
    v_mov_b32 v172, 0
    v_mov_b32 v173, 0
    v_mov_b32 v174, 0
    v_mov_b32 v175, 0
    v_mov_b32 v176, 0
    v_mov_b32 v177, 0
    v_mov_b32 v178, 0
    v_mov_b32 v179, 0
    v_mov_b32 v180, 0
    v_mov_b32 v181, 0
    v_mov_b32 v182, 0
    v_mov_b32 v183, 0
    v_mov_b32 v184, 0
    v_mov_b32 v185, 0
    v_mov_b32 v186, 0
    v_mov_b32 v187, 0
    v_mov_b32 v188, 0
    v_mov_b32 v189, 0
    v_mov_b32 v190, 0
    v_mov_b32 v191, 0
    v_mov_b32 v192, 0
    v_mov_b32 v193, 0
    v_mov_b32 v194, 0
    v_mov_b32 v195, 0
    v_mov_b32 v196, 0
    v_mov_b32 v197, 0
    v_mov_b32 v198, 0
    v_mov_b32 v199, 0
    v_mov_b32 v200, 0
    v_mov_b32 v201, 0
    v_mov_b32 v202, 0
    v_mov_b32 v203, 0
    v_mov_b32 v204, 0
    v_mov_b32 v205, 0
    v_mov_b32 v206, 0
    v_mov_b32 v207, 0
    v_mov_b32 v208, 0
    v_mov_b32 v209, 0
    v_mov_b32 v210, 0
    v_mov_b32 v211, 0
    v_mov_b32 v212, 0
    v_mov_b32 v213, 0
    v_mov_b32 v214, 0
    v_mov_b32 v215, 0
    v_mov_b32 v216, 0
    v_mov_b32 v217, 0
    v_mov_b32 v218, 0
    v_mov_b32 v219, 0
    v_mov_b32 v220, 0
    v_mov_b32 v221, 0
    v_mov_b32 v222, 0
    v_mov_b32 v223, 0
    v_mov_b32 v224, 0
    v_mov_b32 v225, 0
    v_mov_b32 v226, 0
    v_mov_b32 v227, 0
    v_mov_b32 v228, 0
    v_mov_b32 v229, 0
    v_mov_b32 v230, 0
    v_mov_b32 v231, 0
    v_mov_b32 v232, 0
    v_mov_b32 v233, 0
    v_mov_b32 v234, 0
    v_mov_b32 v235, 0
    v_mov_b32 v236, 0
    v_mov_b32 v237, 0
    v_mov_b32 v238, 0
    v_mov_b32 v239, 0
    v_mov_b32 v240, 0
    v_mov_b32 v241, 0
    v_mov_b32 v242, 0
    v_mov_b32 v243, 0
    v_mov_b32 v244, 0
    v_mov_b32 v245, 0
    v_mov_b32 v246, 0
    v_mov_b32 v247, 0
    v_mov_b32 v248, 0
    v_mov_b32 v249, 0
    v_mov_b32 v250, 0
    v_mov_b32 v251, 0
    v_mov_b32 v252, 0
    v_mov_b32 v253, 0
    v_mov_b32 v254, 0
    v_mov_b32 v255, 0
    v_mov_b32 v48, 0
    v_mov_b32 v49, 0
    v_mov_b32 v50, 0
    v_mov_b32 v51, 0
    v_mov_b32 v52, 0
    v_mov_b32 v53, 0
    v_mov_b32 v54, 0
    v_mov_b32 v55, 0
    s_mov_b32 s36, 0
L_slow2:
    s_add_u32 s37, s36, 0
    s_add_u32 s38, s37, 4096
    s_add_u32 s39, s37, 8192
    s_add_u32 s40, s37, 12288
    buffer_load_dwordx4 a[64:67], v1, s[12:15], s37 offen offset:0 sc1
    buffer_load_dwordx4 a[68:71], v1, s[12:15], s37 offen offset:1024 sc1
    buffer_load_dwordx4 a[72:75], v1, s[12:15], s37 offen offset:2048 sc1
    buffer_load_dwordx4 a[76:79], v1, s[12:15], s37 offen offset:3072 sc1
    buffer_load_dwordx4 a[80:83], v1, s[12:15], s38 offen offset:0 sc1
    buffer_load_dwordx4 a[84:87], v1, s[12:15], s38 offen offset:1024 sc1
    buffer_load_dwordx4 a[88:91], v1, s[12:15], s38 offen offset:2048 sc1
    buffer_load_dwordx4 a[92:95], v1, s[12:15], s38 offen offset:3072 sc1
    buffer_load_dwordx4 a[128:131], v1, s[12:15], s39 offen offset:0 sc1
    buffer_load_dwordx4 a[136:139], v1, s[12:15], s39 offen offset:1024 sc1
    buffer_load_dwordx4 a[144:147], v1, s[12:15], s39 offen offset:2048 sc1
    buffer_load_dwordx4 a[152:155], v1, s[12:15], s39 offen offset:3072 sc1
    buffer_load_dwordx4 a[160:163], v1, s[12:15], s40 offen offset:0 sc1
    buffer_load_dwordx4 a[168:171], v1, s[12:15], s40 offen offset:1024 sc1
    buffer_load_dwordx4 a[176:179], v1, s[12:15], s40 offen offset:2048 sc1
    buffer_load_dwordx4 a[184:187], v1, s[12:15], s40 offen offset:3072 sc1
    s_add_u32 s37, s36, 16384
    s_add_u32 s38, s37, 4096
    s_add_u32 s39, s37, 8192
    s_add_u32 s40, s37, 12288
    buffer_load_dwordx4 a[96:99], v1, s[12:15], s37 offen offset:0 sc1
    buffer_load_dwordx4 a[100:103], v1, s[12:15], s37 offen offset:1024 sc1
    buffer_load_dwordx4 a[104:107], v1, s[12:15], s37 offen offset:2048 sc1
    buffer_load_dwordx4 a[108:111], v1, s[12:15], s37 offen offset:3072 sc1
    buffer_load_dwordx4 a[112:115], v1, s[12:15], s38 offen offset:0 sc1
    buffer_load_dwordx4 a[116:119], v1, s[12:15], s38 offen offset:1024 sc1
    buffer_load_dwordx4 a[120:123], v1, s[12:15], s38 offen offset:2048 sc1
    buffer_load_dwordx4 a[124:127], v1, s[12:15], s38 offen offset:3072 sc1
    buffer_load_dwordx4 a[132:135], v1, s[12:15], s39 offen offset:0 sc1
    buffer_load_dwordx4 a[140:143], v1, s[12:15], s39 offen offset:1024 sc1
    buffer_load_dwordx4 a[148:151], v1, s[12:15], s39 offen offset:2048 sc1
    buffer_load_dwordx4 a[156:159], v1, s[12:15], s39 offen offset:3072 sc1
    buffer_load_dwordx4 a[164:167], v1, s[12:15], s40 offen offset:0 sc1
    buffer_load_dwordx4 a[172:175], v1, s[12:15], s40 offen offset:1024 sc1
    buffer_load_dwordx4 a[180:183], v1, s[12:15], s40 offen offset:2048 sc1
    buffer_load_dwordx4 a[188:191], v1, s[12:15], s40 offen offset:3072 sc1
    s_waitcnt vmcnt(0)
    v_mfma_f32_16x16x32_bf16 v[64:67], a[64:67], a[0:3], v[32:35]
    v_mfma_f32_16x16x32_bf16 v[64:67], a[68:71], a[4:7], v[64:67]
    v_mfma_f32_16x16x32_bf16 v[64:67], a[72:75], a[8:11], v[64:67]
    v_mfma_f32_16x16x32_bf16 v[64:67], a[76:79], a[12:15], v[64:67]
    v_mfma_f32_16x16x32_bf16 v[68:71], a[92:95], a[12:15], v[32:35]
    v_mfma_f32_16x16x32_bf16 v[68:71], a[88:91], a[8:11], v[68:71]
    v_mfma_f32_16x16x32_bf16 v[68:71], a[84:87], a[4:7], v[68:71]
    v_mfma_f32_16x16x32_bf16 v[68:71], a[80:83], a[0:3], v[68:71]
    v_mfma_f32_16x16x32_bf16 v[84:87], a[80:83], a[16:19], v[36:39]
    v_mfma_f32_16x16x32_bf16 v[84:87], a[84:87], a[20:23], v[84:87]
    v_mfma_f32_16x16x32_bf16 v[84:87], a[88:91], a[24:27], v[84:87]
    v_mfma_f32_16x16x32_bf16 v[84:87], a[92:95], a[28:31], v[84:87]
    v_mfma_f32_16x16x32_bf16 v[80:83], a[76:79], a[28:31], v[36:39]
    v_mfma_f32_16x16x32_bf16 v[80:83], a[72:75], a[24:27], v[80:83]
    v_mfma_f32_16x16x32_bf16 v[80:83], a[68:71], a[20:23], v[80:83]
    v_mfma_f32_16x16x32_bf16 v[80:83], a[64:67], a[16:19], v[80:83]
    v_mfma_f32_16x16x32_bf16 v[88:91], a[96:99], a[16:19], v[36:39]
    v_mfma_f32_16x16x32_bf16 v[88:91], a[100:103], a[20:23], v[88:91]
    v_mfma_f32_16x16x32_bf16 v[88:91], a[104:107], a[24:27], v[88:91]
    v_mfma_f32_16x16x32_bf16 v[88:91], a[108:111], a[28:31], v[88:91]
    v_mfma_f32_16x16x32_bf16 v[92:95], a[124:127], a[28:31], v[36:39]
    v_mfma_f32_16x16x32_bf16 v[92:95], a[120:123], a[24:27], v[92:95]
    v_mfma_f32_16x16x32_bf16 v[92:95], a[116:119], a[20:23], v[92:95]
    v_mfma_f32_16x16x32_bf16 v[92:95], a[112:115], a[16:19], v[92:95]
    v_mfma_f32_16x16x32_bf16 v[76:79], a[112:115], a[0:3], v[32:35]
    v_mfma_f32_16x16x32_bf16 v[76:79], a[116:119], a[4:7], v[76:79]
    v_mfma_f32_16x16x32_bf16 v[76:79], a[120:123], a[8:11], v[76:79]
    v_mfma_f32_16x16x32_bf16 v[76:79], a[124:127], a[12:15], v[76:79]
    v_mfma_f32_16x16x32_bf16 v[72:75], a[108:111], a[12:15], v[32:35]
    v_mfma_f32_16x16x32_bf16 v[72:75], a[104:107], a[8:11], v[72:75]
    v_mfma_f32_16x16x32_bf16 v[72:75], a[100:103], a[4:7], v[72:75]
    v_mfma_f32_16x16x32_bf16 v[72:75], a[96:99], a[0:3], v[72:75]
    v_mfma_f32_16x16x32_bf16 v[96:99], a[64:67], a[32:35], v[40:43]
    v_mfma_f32_16x16x32_bf16 v[96:99], a[68:71], a[36:39], v[96:99]
    v_mfma_f32_16x16x32_bf16 v[96:99], a[72:75], a[40:43], v[96:99]
    v_mfma_f32_16x16x32_bf16 v[96:99], a[76:79], a[44:47], v[96:99]
    v_mfma_f32_16x16x32_bf16 v[100:103], a[92:95], a[44:47], v[40:43]
    v_mfma_f32_16x16x32_bf16 v[100:103], a[88:91], a[40:43], v[100:103]
    v_mfma_f32_16x16x32_bf16 v[100:103], a[84:87], a[36:39], v[100:103]
    v_mfma_f32_16x16x32_bf16 v[100:103], a[80:83], a[32:35], v[100:103]
    v_mfma_f32_16x16x32_bf16 v[116:119], a[80:83], a[48:51], v[44:47]
    v_mfma_f32_16x16x32_bf16 v[116:119], a[84:87], a[52:55], v[116:119]
    v_mfma_f32_16x16x32_bf16 v[116:119], a[88:91], a[56:59], v[116:119]
    v_mfma_f32_16x16x32_bf16 v[116:119], a[92:95], a[60:63], v[116:119]
    v_mfma_f32_16x16x32_bf16 v[112:115], a[76:79], a[60:63], v[44:47]
    v_mfma_f32_16x16x32_bf16 v[112:115], a[72:75], a[56:59], v[112:115]
    v_mfma_f32_16x16x32_bf16 v[112:115], a[68:71], a[52:55], v[112:115]
    v_mfma_f32_16x16x32_bf16 v[112:115], a[64:67], a[48:51], v[112:115]
    v_mfma_f32_16x16x32_bf16 v[120:123], a[96:99], a[48:51], v[44:47]
    v_mfma_f32_16x16x32_bf16 v[120:123], a[100:103], a[52:55], v[120:123]
    v_mfma_f32_16x16x32_bf16 v[120:123], a[104:107], a[56:59], v[120:123]
    v_mfma_f32_16x16x32_bf16 v[120:123], a[108:111], a[60:63], v[120:123]
    v_mfma_f32_16x16x32_bf16 v[124:127], a[124:127], a[60:63], v[44:47]
    v_mfma_f32_16x16x32_bf16 v[124:127], a[120:123], a[56:59], v[124:127]
    v_mfma_f32_16x16x32_bf16 v[124:127], a[116:119], a[52:55], v[124:127]
    v_mfma_f32_16x16x32_bf16 v[124:127], a[112:115], a[48:51], v[124:127]
    v_mfma_f32_16x16x32_bf16 v[108:111], a[112:115], a[32:35], v[40:43]
    v_mfma_f32_16x16x32_bf16 v[108:111], a[116:119], a[36:39], v[108:111]
    v_mfma_f32_16x16x32_bf16 v[108:111], a[120:123], a[40:43], v[108:111]
    v_mfma_f32_16x16x32_bf16 v[108:111], a[124:127], a[44:47], v[108:111]
    v_mfma_f32_16x16x32_bf16 v[104:107], a[108:111], a[44:47], v[40:43]
    v_mfma_f32_16x16x32_bf16 v[104:107], a[104:107], a[40:43], v[104:107]
    v_mfma_f32_16x16x32_bf16 v[104:107], a[100:103], a[36:39], v[104:107]
    v_mfma_f32_16x16x32_bf16 v[104:107], a[96:99], a[32:35], v[104:107]
    s_nop 7
    v_exp_f32 v64, v64
    v_exp_f32 v65, v65
    v_exp_f32 v66, v66
    v_exp_f32 v67, v67
    v_exp_f32 v68, v68
    v_exp_f32 v69, v69
    v_exp_f32 v70, v70
    v_exp_f32 v71, v71
    v_exp_f32 v80, v80
    v_exp_f32 v81, v81
    v_exp_f32 v82, v82
    v_exp_f32 v83, v83
    v_exp_f32 v84, v84
    v_exp_f32 v85, v85
    v_exp_f32 v86, v86
    v_exp_f32 v87, v87
    v_exp_f32 v88, v88
    v_exp_f32 v89, v89
    v_exp_f32 v90, v90
    v_exp_f32 v91, v91
    v_exp_f32 v92, v92
    v_exp_f32 v93, v93
    v_exp_f32 v94, v94
    v_exp_f32 v95, v95
    v_exp_f32 v72, v72
    v_exp_f32 v73, v73
    v_exp_f32 v74, v74
    v_exp_f32 v75, v75
    v_exp_f32 v76, v76
    v_exp_f32 v77, v77
    v_exp_f32 v78, v78
    v_exp_f32 v79, v79
    v_cvt_pk_bf16_f32 v64, v64, v65
    v_cvt_pk_bf16_f32 v65, v66, v67
    v_cvt_pk_bf16_f32 v66, v68, v69
    v_cvt_pk_bf16_f32 v67, v70, v71
    v_cvt_pk_bf16_f32 v80, v80, v81
    v_cvt_pk_bf16_f32 v81, v82, v83
    v_cvt_pk_bf16_f32 v82, v84, v85
    v_cvt_pk_bf16_f32 v83, v86, v87
    v_cvt_pk_bf16_f32 v84, v88, v89
    v_cvt_pk_bf16_f32 v85, v90, v91
    v_cvt_pk_bf16_f32 v86, v92, v93
    v_cvt_pk_bf16_f32 v87, v94, v95
    v_cvt_pk_bf16_f32 v68, v72, v73
    v_cvt_pk_bf16_f32 v69, v74, v75
    v_cvt_pk_bf16_f32 v70, v76, v77
    v_cvt_pk_bf16_f32 v71, v78, v79
    v_exp_f32 v96, v96
    v_exp_f32 v97, v97
    v_exp_f32 v98, v98
    v_exp_f32 v99, v99
    v_exp_f32 v100, v100
    v_exp_f32 v101, v101
    v_exp_f32 v102, v102
    v_exp_f32 v103, v103
    v_exp_f32 v112, v112
    v_exp_f32 v113, v113
    v_exp_f32 v114, v114
    v_exp_f32 v115, v115
    v_exp_f32 v116, v116
    v_exp_f32 v117, v117
    v_exp_f32 v118, v118
    v_exp_f32 v119, v119
    v_exp_f32 v120, v120
    v_exp_f32 v121, v121
    v_exp_f32 v122, v122
    v_exp_f32 v123, v123
    v_exp_f32 v124, v124
    v_exp_f32 v125, v125
    v_exp_f32 v126, v126
    v_exp_f32 v127, v127
    v_exp_f32 v104, v104
    v_exp_f32 v105, v105
    v_exp_f32 v106, v106
    v_exp_f32 v107, v107
    v_exp_f32 v108, v108
    v_exp_f32 v109, v109
    v_exp_f32 v110, v110
    v_exp_f32 v111, v111
    v_cvt_pk_bf16_f32 v96, v96, v97
    v_cvt_pk_bf16_f32 v97, v98, v99
    v_cvt_pk_bf16_f32 v98, v100, v101
    v_cvt_pk_bf16_f32 v99, v102, v103
    v_cvt_pk_bf16_f32 v112, v112, v113
    v_cvt_pk_bf16_f32 v113, v114, v115
    v_cvt_pk_bf16_f32 v114, v116, v117
    v_cvt_pk_bf16_f32 v115, v118, v119
    v_cvt_pk_bf16_f32 v116, v120, v121
    v_cvt_pk_bf16_f32 v117, v122, v123
    v_cvt_pk_bf16_f32 v118, v124, v125
    v_cvt_pk_bf16_f32 v119, v126, v127
    v_cvt_pk_bf16_f32 v100, v104, v105
    v_cvt_pk_bf16_f32 v101, v106, v107
    v_cvt_pk_bf16_f32 v102, v108, v109
    v_cvt_pk_bf16_f32 v103, v110, v111
    v_mfma_f32_16x16x32_bf16 v[128:131], v[64:67], a[128:131], v[128:131]
    v_mfma_f32_16x16x32_bf16 v[128:131], v[68:71], a[132:135], v[128:131]
    v_mfma_f32_16x16x32_bf16 v[132:135], v[68:71], a[140:143], v[132:135]
    v_mfma_f32_16x16x32_bf16 v[132:135], v[64:67], a[136:139], v[132:135]
    v_mfma_f32_16x16x32_bf16 v[136:139], v[64:67], a[144:147], v[136:139]
    v_mfma_f32_16x16x32_bf16 v[136:139], v[68:71], a[148:151], v[136:139]
    v_mfma_f32_16x16x32_bf16 v[140:143], v[68:71], a[156:159], v[140:143]
    v_mfma_f32_16x16x32_bf16 v[140:143], v[64:67], a[152:155], v[140:143]
    v_mfma_f32_16x16x32_bf16 v[172:175], v[80:83], a[152:155], v[172:175]
    v_mfma_f32_16x16x32_bf16 v[172:175], v[84:87], a[156:159], v[172:175]
    v_mfma_f32_16x16x32_bf16 v[168:171], v[84:87], a[148:151], v[168:171]
    v_mfma_f32_16x16x32_bf16 v[168:171], v[80:83], a[144:147], v[168:171]
    v_mfma_f32_16x16x32_bf16 v[164:167], v[80:83], a[136:139], v[164:167]
    v_mfma_f32_16x16x32_bf16 v[164:167], v[84:87], a[140:143], v[164:167]
    v_mfma_f32_16x16x32_bf16 v[160:163], v[84:87], a[132:135], v[160:163]
    v_mfma_f32_16x16x32_bf16 v[160:163], v[80:83], a[128:131], v[160:163]
    v_mfma_f32_16x16x32_bf16 v[176:179], v[80:83], a[160:163], v[176:179]
    v_mfma_f32_16x16x32_bf16 v[176:179], v[84:87], a[164:167], v[176:179]
    v_mfma_f32_16x16x32_bf16 v[180:183], v[84:87], a[172:175], v[180:183]
    v_mfma_f32_16x16x32_bf16 v[180:183], v[80:83], a[168:171], v[180:183]
    v_mfma_f32_16x16x32_bf16 v[184:187], v[80:83], a[176:179], v[184:187]
    v_mfma_f32_16x16x32_bf16 v[184:187], v[84:87], a[180:183], v[184:187]
    v_mfma_f32_16x16x32_bf16 v[188:191], v[84:87], a[188:191], v[188:191]
    v_mfma_f32_16x16x32_bf16 v[188:191], v[80:83], a[184:187], v[188:191]
    v_mfma_f32_16x16x32_bf16 v[156:159], v[64:67], a[184:187], v[156:159]
    v_mfma_f32_16x16x32_bf16 v[156:159], v[68:71], a[188:191], v[156:159]
    v_mfma_f32_16x16x32_bf16 v[152:155], v[68:71], a[180:183], v[152:155]
    v_mfma_f32_16x16x32_bf16 v[152:155], v[64:67], a[176:179], v[152:155]
    v_mfma_f32_16x16x32_bf16 v[148:151], v[64:67], a[168:171], v[148:151]
    v_mfma_f32_16x16x32_bf16 v[148:151], v[68:71], a[172:175], v[148:151]
    v_mfma_f32_16x16x32_bf16 v[144:147], v[68:71], a[164:167], v[144:147]
    v_mfma_f32_16x16x32_bf16 v[144:147], v[64:67], a[160:163], v[144:147]
    v_mfma_f32_16x16x32_bf16 v[192:195], v[96:99], a[128:131], v[192:195]
    v_mfma_f32_16x16x32_bf16 v[192:195], v[100:103], a[132:135], v[192:195]
    v_mfma_f32_16x16x32_bf16 v[196:199], v[100:103], a[140:143], v[196:199]
    v_mfma_f32_16x16x32_bf16 v[196:199], v[96:99], a[136:139], v[196:199]
    v_mfma_f32_16x16x32_bf16 v[200:203], v[96:99], a[144:147], v[200:203]
    v_mfma_f32_16x16x32_bf16 v[200:203], v[100:103], a[148:151], v[200:203]
    v_mfma_f32_16x16x32_bf16 v[204:207], v[100:103], a[156:159], v[204:207]
    v_mfma_f32_16x16x32_bf16 v[204:207], v[96:99], a[152:155], v[204:207]
    v_mfma_f32_16x16x32_bf16 v[236:239], v[112:115], a[152:155], v[236:239]
    v_mfma_f32_16x16x32_bf16 v[236:239], v[116:119], a[156:159], v[236:239]
    v_mfma_f32_16x16x32_bf16 v[232:235], v[116:119], a[148:151], v[232:235]
    v_mfma_f32_16x16x32_bf16 v[232:235], v[112:115], a[144:147], v[232:235]
    v_mfma_f32_16x16x32_bf16 v[228:231], v[112:115], a[136:139], v[228:231]
    v_mfma_f32_16x16x32_bf16 v[228:231], v[116:119], a[140:143], v[228:231]
    v_mfma_f32_16x16x32_bf16 v[224:227], v[116:119], a[132:135], v[224:227]
    v_mfma_f32_16x16x32_bf16 v[224:227], v[112:115], a[128:131], v[224:227]
    v_mfma_f32_16x16x32_bf16 v[240:243], v[112:115], a[160:163], v[240:243]
    v_mfma_f32_16x16x32_bf16 v[240:243], v[116:119], a[164:167], v[240:243]
    v_mfma_f32_16x16x32_bf16 v[244:247], v[116:119], a[172:175], v[244:247]
    v_mfma_f32_16x16x32_bf16 v[244:247], v[112:115], a[168:171], v[244:247]
    v_mfma_f32_16x16x32_bf16 v[248:251], v[112:115], a[176:179], v[248:251]
    v_mfma_f32_16x16x32_bf16 v[248:251], v[116:119], a[180:183], v[248:251]
    v_mfma_f32_16x16x32_bf16 v[252:255], v[116:119], a[188:191], v[252:255]
    v_mfma_f32_16x16x32_bf16 v[252:255], v[112:115], a[184:187], v[252:255]
    v_mfma_f32_16x16x32_bf16 v[220:223], v[96:99], a[184:187], v[220:223]
    v_mfma_f32_16x16x32_bf16 v[220:223], v[100:103], a[188:191], v[220:223]
    v_mfma_f32_16x16x32_bf16 v[216:219], v[100:103], a[180:183], v[216:219]
    v_mfma_f32_16x16x32_bf16 v[216:219], v[96:99], a[176:179], v[216:219]
    v_mfma_f32_16x16x32_bf16 v[212:215], v[96:99], a[168:171], v[212:215]
    v_mfma_f32_16x16x32_bf16 v[212:215], v[100:103], a[172:175], v[212:215]
    v_mfma_f32_16x16x32_bf16 v[208:211], v[100:103], a[164:167], v[208:211]
    v_mfma_f32_16x16x32_bf16 v[208:211], v[96:99], a[160:163], v[208:211]
    v_smfmac_f32_16x16x64_bf16 v[48:51], a[192:195], v[64:71], v11
    v_smfmac_f32_16x16x64_bf16 v[48:51], a[196:199], v[80:87], v11
    v_smfmac_f32_16x16x64_bf16 v[52:55], a[192:195], v[96:103], v11
    v_smfmac_f32_16x16x64_bf16 v[52:55], a[196:199], v[112:119], v11
    s_nop 7
    s_add_u32 s36, s36, 0x8000
    s_cmp_lt_u32 s36, 0x100000
    s_cbranch_scc1 L_slow2
    v_add_f32 v12, v48, v49
    v_add_f32 v13, v50, v51
    v_add_f32 v14, v52, v53
    v_add_f32 v15, v54, v55
    v_rcp_f32 v20, v12
    v_rcp_f32 v21, v13
    v_rcp_f32 v22, v14
    v_rcp_f32 v23, v15
    v_lshrrev_b32 v16, 4, v0
    v_and_b32 v4, 15, v0
    v_lshlrev_b32 v4, 4, v4
    v_lshl_add_u32 v4, v16, 10, v4
    v_lshlrev_b32 v16, 4, v16
    v_add_u32 v17, 4, v16
    v_add_u32 v18, 8, v16
    v_add_u32 v19, 12, v16
    ds_bpermute_b32 v24, v16, v20
    ds_bpermute_b32 v25, v17, v20
    ds_bpermute_b32 v26, v18, v20
    ds_bpermute_b32 v27, v19, v20
    s_waitcnt lgkmcnt(0)
    v_mul_f32 v56, s99, v24
    v_mul_f32 v57, s99, v25
    v_pk_fma_f32 v[128:129], v[128:129], v[24:25], v[56:57] neg_lo:[0,0,1] neg_hi:[0,0,1]
    v_pk_fma_f32 v[132:133], v[132:133], v[24:25], v[56:57] neg_lo:[0,0,1] neg_hi:[0,0,1]
    v_pk_fma_f32 v[136:137], v[136:137], v[24:25], v[56:57] neg_lo:[0,0,1] neg_hi:[0,0,1]
    v_pk_fma_f32 v[140:141], v[140:141], v[24:25], v[56:57] neg_lo:[0,0,1] neg_hi:[0,0,1]
    v_pk_fma_f32 v[144:145], v[144:145], v[24:25], v[56:57] neg_lo:[0,0,1] neg_hi:[0,0,1]
    v_pk_fma_f32 v[148:149], v[148:149], v[24:25], v[56:57] neg_lo:[0,0,1] neg_hi:[0,0,1]
    v_pk_fma_f32 v[152:153], v[152:153], v[24:25], v[56:57] neg_lo:[0,0,1] neg_hi:[0,0,1]
    v_pk_fma_f32 v[156:157], v[156:157], v[24:25], v[56:57] neg_lo:[0,0,1] neg_hi:[0,0,1]
    v_cvt_pk_bf16_f32 v64, v128, v132
    v_cvt_pk_bf16_f32 v65, v136, v140
    v_cvt_pk_bf16_f32 v66, v144, v148
    v_cvt_pk_bf16_f32 v67, v152, v156
    buffer_store_dwordx4 v[64:67], v4, s[16:19], s31 offen offset:0 sc0 sc1
    v_cvt_pk_bf16_f32 v68, v129, v133
    v_cvt_pk_bf16_f32 v69, v137, v141
    v_cvt_pk_bf16_f32 v70, v145, v149
    v_cvt_pk_bf16_f32 v71, v153, v157
    buffer_store_dwordx4 v[68:71], v4, s[16:19], s31 offen offset:256 sc0 sc1
    v_mul_f32 v56, s99, v26
    v_mul_f32 v57, s99, v27
    v_pk_fma_f32 v[130:131], v[130:131], v[26:27], v[56:57] neg_lo:[0,0,1] neg_hi:[0,0,1]
    v_pk_fma_f32 v[134:135], v[134:135], v[26:27], v[56:57] neg_lo:[0,0,1] neg_hi:[0,0,1]
    v_pk_fma_f32 v[138:139], v[138:139], v[26:27], v[56:57] neg_lo:[0,0,1] neg_hi:[0,0,1]
    v_pk_fma_f32 v[142:143], v[142:143], v[26:27], v[56:57] neg_lo:[0,0,1] neg_hi:[0,0,1]
    v_pk_fma_f32 v[146:147], v[146:147], v[26:27], v[56:57] neg_lo:[0,0,1] neg_hi:[0,0,1]
    v_pk_fma_f32 v[150:151], v[150:151], v[26:27], v[56:57] neg_lo:[0,0,1] neg_hi:[0,0,1]
    v_pk_fma_f32 v[154:155], v[154:155], v[26:27], v[56:57] neg_lo:[0,0,1] neg_hi:[0,0,1]
    v_pk_fma_f32 v[158:159], v[158:159], v[26:27], v[56:57] neg_lo:[0,0,1] neg_hi:[0,0,1]
    v_cvt_pk_bf16_f32 v72, v130, v134
    v_cvt_pk_bf16_f32 v73, v138, v142
    v_cvt_pk_bf16_f32 v74, v146, v150
    v_cvt_pk_bf16_f32 v75, v154, v158
    buffer_store_dwordx4 v[72:75], v4, s[16:19], s31 offen offset:512 sc0 sc1
    v_cvt_pk_bf16_f32 v76, v131, v135
    v_cvt_pk_bf16_f32 v77, v139, v143
    v_cvt_pk_bf16_f32 v78, v147, v151
    v_cvt_pk_bf16_f32 v79, v155, v159
    buffer_store_dwordx4 v[76:79], v4, s[16:19], s31 offen offset:768 sc0 sc1
    ds_bpermute_b32 v28, v16, v21
    ds_bpermute_b32 v29, v17, v21
    ds_bpermute_b32 v30, v18, v21
    ds_bpermute_b32 v31, v19, v21
    s_waitcnt lgkmcnt(0)
    v_mul_f32 v56, s99, v28
    v_mul_f32 v57, s99, v29
    v_pk_fma_f32 v[160:161], v[160:161], v[28:29], v[56:57] neg_lo:[0,0,1] neg_hi:[0,0,1]
    v_pk_fma_f32 v[164:165], v[164:165], v[28:29], v[56:57] neg_lo:[0,0,1] neg_hi:[0,0,1]
    v_pk_fma_f32 v[168:169], v[168:169], v[28:29], v[56:57] neg_lo:[0,0,1] neg_hi:[0,0,1]
    v_pk_fma_f32 v[172:173], v[172:173], v[28:29], v[56:57] neg_lo:[0,0,1] neg_hi:[0,0,1]
    v_pk_fma_f32 v[176:177], v[176:177], v[28:29], v[56:57] neg_lo:[0,0,1] neg_hi:[0,0,1]
    v_pk_fma_f32 v[180:181], v[180:181], v[28:29], v[56:57] neg_lo:[0,0,1] neg_hi:[0,0,1]
    v_pk_fma_f32 v[184:185], v[184:185], v[28:29], v[56:57] neg_lo:[0,0,1] neg_hi:[0,0,1]
    v_pk_fma_f32 v[188:189], v[188:189], v[28:29], v[56:57] neg_lo:[0,0,1] neg_hi:[0,0,1]
    v_cvt_pk_bf16_f32 v80, v160, v164
    v_cvt_pk_bf16_f32 v81, v168, v172
    v_cvt_pk_bf16_f32 v82, v176, v180
    v_cvt_pk_bf16_f32 v83, v184, v188
    buffer_store_dwordx4 v[80:83], v4, s[16:19], s32 offen offset:0 sc0 sc1
    v_cvt_pk_bf16_f32 v84, v161, v165
    v_cvt_pk_bf16_f32 v85, v169, v173
    v_cvt_pk_bf16_f32 v86, v177, v181
    v_cvt_pk_bf16_f32 v87, v185, v189
    buffer_store_dwordx4 v[84:87], v4, s[16:19], s32 offen offset:256 sc0 sc1
    v_mul_f32 v56, s99, v30
    v_mul_f32 v57, s99, v31
    v_pk_fma_f32 v[162:163], v[162:163], v[30:31], v[56:57] neg_lo:[0,0,1] neg_hi:[0,0,1]
    v_pk_fma_f32 v[166:167], v[166:167], v[30:31], v[56:57] neg_lo:[0,0,1] neg_hi:[0,0,1]
    v_pk_fma_f32 v[170:171], v[170:171], v[30:31], v[56:57] neg_lo:[0,0,1] neg_hi:[0,0,1]
    v_pk_fma_f32 v[174:175], v[174:175], v[30:31], v[56:57] neg_lo:[0,0,1] neg_hi:[0,0,1]
    v_pk_fma_f32 v[178:179], v[178:179], v[30:31], v[56:57] neg_lo:[0,0,1] neg_hi:[0,0,1]
    v_pk_fma_f32 v[182:183], v[182:183], v[30:31], v[56:57] neg_lo:[0,0,1] neg_hi:[0,0,1]
    v_pk_fma_f32 v[186:187], v[186:187], v[30:31], v[56:57] neg_lo:[0,0,1] neg_hi:[0,0,1]
    v_pk_fma_f32 v[190:191], v[190:191], v[30:31], v[56:57] neg_lo:[0,0,1] neg_hi:[0,0,1]
    v_cvt_pk_bf16_f32 v88, v162, v166
    v_cvt_pk_bf16_f32 v89, v170, v174
    v_cvt_pk_bf16_f32 v90, v178, v182
    v_cvt_pk_bf16_f32 v91, v186, v190
    buffer_store_dwordx4 v[88:91], v4, s[16:19], s32 offen offset:512 sc0 sc1
    v_cvt_pk_bf16_f32 v92, v163, v167
    v_cvt_pk_bf16_f32 v93, v171, v175
    v_cvt_pk_bf16_f32 v94, v179, v183
    v_cvt_pk_bf16_f32 v95, v187, v191
    buffer_store_dwordx4 v[92:95], v4, s[16:19], s32 offen offset:768 sc0 sc1
    ds_bpermute_b32 v24, v16, v22
    ds_bpermute_b32 v25, v17, v22
    ds_bpermute_b32 v26, v18, v22
    ds_bpermute_b32 v27, v19, v22
    s_waitcnt lgkmcnt(0)
    v_mul_f32 v56, s99, v24
    v_mul_f32 v57, s99, v25
    v_pk_fma_f32 v[192:193], v[192:193], v[24:25], v[56:57] neg_lo:[0,0,1] neg_hi:[0,0,1]
    v_pk_fma_f32 v[196:197], v[196:197], v[24:25], v[56:57] neg_lo:[0,0,1] neg_hi:[0,0,1]
    v_pk_fma_f32 v[200:201], v[200:201], v[24:25], v[56:57] neg_lo:[0,0,1] neg_hi:[0,0,1]
    v_pk_fma_f32 v[204:205], v[204:205], v[24:25], v[56:57] neg_lo:[0,0,1] neg_hi:[0,0,1]
    v_pk_fma_f32 v[208:209], v[208:209], v[24:25], v[56:57] neg_lo:[0,0,1] neg_hi:[0,0,1]
    v_pk_fma_f32 v[212:213], v[212:213], v[24:25], v[56:57] neg_lo:[0,0,1] neg_hi:[0,0,1]
    v_pk_fma_f32 v[216:217], v[216:217], v[24:25], v[56:57] neg_lo:[0,0,1] neg_hi:[0,0,1]
    v_pk_fma_f32 v[220:221], v[220:221], v[24:25], v[56:57] neg_lo:[0,0,1] neg_hi:[0,0,1]
    v_cvt_pk_bf16_f32 v96, v192, v196
    v_cvt_pk_bf16_f32 v97, v200, v204
    v_cvt_pk_bf16_f32 v98, v208, v212
    v_cvt_pk_bf16_f32 v99, v216, v220
    buffer_store_dwordx4 v[96:99], v4, s[16:19], s33 offen offset:0 sc0 sc1
    v_cvt_pk_bf16_f32 v100, v193, v197
    v_cvt_pk_bf16_f32 v101, v201, v205
    v_cvt_pk_bf16_f32 v102, v209, v213
    v_cvt_pk_bf16_f32 v103, v217, v221
    buffer_store_dwordx4 v[100:103], v4, s[16:19], s33 offen offset:256 sc0 sc1
    v_mul_f32 v56, s99, v26
    v_mul_f32 v57, s99, v27
    v_pk_fma_f32 v[194:195], v[194:195], v[26:27], v[56:57] neg_lo:[0,0,1] neg_hi:[0,0,1]
    v_pk_fma_f32 v[198:199], v[198:199], v[26:27], v[56:57] neg_lo:[0,0,1] neg_hi:[0,0,1]
    v_pk_fma_f32 v[202:203], v[202:203], v[26:27], v[56:57] neg_lo:[0,0,1] neg_hi:[0,0,1]
    v_pk_fma_f32 v[206:207], v[206:207], v[26:27], v[56:57] neg_lo:[0,0,1] neg_hi:[0,0,1]
    v_pk_fma_f32 v[210:211], v[210:211], v[26:27], v[56:57] neg_lo:[0,0,1] neg_hi:[0,0,1]
    v_pk_fma_f32 v[214:215], v[214:215], v[26:27], v[56:57] neg_lo:[0,0,1] neg_hi:[0,0,1]
    v_pk_fma_f32 v[218:219], v[218:219], v[26:27], v[56:57] neg_lo:[0,0,1] neg_hi:[0,0,1]
    v_pk_fma_f32 v[222:223], v[222:223], v[26:27], v[56:57] neg_lo:[0,0,1] neg_hi:[0,0,1]
    v_cvt_pk_bf16_f32 v104, v194, v198
    v_cvt_pk_bf16_f32 v105, v202, v206
    v_cvt_pk_bf16_f32 v106, v210, v214
    v_cvt_pk_bf16_f32 v107, v218, v222
    buffer_store_dwordx4 v[104:107], v4, s[16:19], s33 offen offset:512 sc0 sc1
    v_cvt_pk_bf16_f32 v108, v195, v199
    v_cvt_pk_bf16_f32 v109, v203, v207
    v_cvt_pk_bf16_f32 v110, v211, v215
    v_cvt_pk_bf16_f32 v111, v219, v223
    buffer_store_dwordx4 v[108:111], v4, s[16:19], s33 offen offset:768 sc0 sc1
    ds_bpermute_b32 v28, v16, v23
    ds_bpermute_b32 v29, v17, v23
    ds_bpermute_b32 v30, v18, v23
    ds_bpermute_b32 v31, v19, v23
    s_waitcnt lgkmcnt(0)
    v_mul_f32 v56, s99, v28
    v_mul_f32 v57, s99, v29
    v_pk_fma_f32 v[224:225], v[224:225], v[28:29], v[56:57] neg_lo:[0,0,1] neg_hi:[0,0,1]
    v_pk_fma_f32 v[228:229], v[228:229], v[28:29], v[56:57] neg_lo:[0,0,1] neg_hi:[0,0,1]
    v_pk_fma_f32 v[232:233], v[232:233], v[28:29], v[56:57] neg_lo:[0,0,1] neg_hi:[0,0,1]
    v_pk_fma_f32 v[236:237], v[236:237], v[28:29], v[56:57] neg_lo:[0,0,1] neg_hi:[0,0,1]
    v_pk_fma_f32 v[240:241], v[240:241], v[28:29], v[56:57] neg_lo:[0,0,1] neg_hi:[0,0,1]
    v_pk_fma_f32 v[244:245], v[244:245], v[28:29], v[56:57] neg_lo:[0,0,1] neg_hi:[0,0,1]
    v_pk_fma_f32 v[248:249], v[248:249], v[28:29], v[56:57] neg_lo:[0,0,1] neg_hi:[0,0,1]
    v_pk_fma_f32 v[252:253], v[252:253], v[28:29], v[56:57] neg_lo:[0,0,1] neg_hi:[0,0,1]
    v_cvt_pk_bf16_f32 v112, v224, v228
    v_cvt_pk_bf16_f32 v113, v232, v236
    v_cvt_pk_bf16_f32 v114, v240, v244
    v_cvt_pk_bf16_f32 v115, v248, v252
    buffer_store_dwordx4 v[112:115], v4, s[16:19], s34 offen offset:0 sc0 sc1
    v_cvt_pk_bf16_f32 v116, v225, v229
    v_cvt_pk_bf16_f32 v117, v233, v237
    v_cvt_pk_bf16_f32 v118, v241, v245
    v_cvt_pk_bf16_f32 v119, v249, v253
    buffer_store_dwordx4 v[116:119], v4, s[16:19], s34 offen offset:256 sc0 sc1
    v_mul_f32 v56, s99, v30
    v_mul_f32 v57, s99, v31
    v_pk_fma_f32 v[226:227], v[226:227], v[30:31], v[56:57] neg_lo:[0,0,1] neg_hi:[0,0,1]
    v_pk_fma_f32 v[230:231], v[230:231], v[30:31], v[56:57] neg_lo:[0,0,1] neg_hi:[0,0,1]
    v_pk_fma_f32 v[234:235], v[234:235], v[30:31], v[56:57] neg_lo:[0,0,1] neg_hi:[0,0,1]
    v_pk_fma_f32 v[238:239], v[238:239], v[30:31], v[56:57] neg_lo:[0,0,1] neg_hi:[0,0,1]
    v_pk_fma_f32 v[242:243], v[242:243], v[30:31], v[56:57] neg_lo:[0,0,1] neg_hi:[0,0,1]
    v_pk_fma_f32 v[246:247], v[246:247], v[30:31], v[56:57] neg_lo:[0,0,1] neg_hi:[0,0,1]
    v_pk_fma_f32 v[250:251], v[250:251], v[30:31], v[56:57] neg_lo:[0,0,1] neg_hi:[0,0,1]
    v_pk_fma_f32 v[254:255], v[254:255], v[30:31], v[56:57] neg_lo:[0,0,1] neg_hi:[0,0,1]
    v_cvt_pk_bf16_f32 v120, v226, v230
    v_cvt_pk_bf16_f32 v121, v234, v238
    v_cvt_pk_bf16_f32 v122, v242, v246
    v_cvt_pk_bf16_f32 v123, v250, v254
    buffer_store_dwordx4 v[120:123], v4, s[16:19], s34 offen offset:512 sc0 sc1
    v_cvt_pk_bf16_f32 v124, v227, v231
    v_cvt_pk_bf16_f32 v125, v235, v239
    v_cvt_pk_bf16_f32 v126, v243, v247
    v_cvt_pk_bf16_f32 v127, v251, v255
    buffer_store_dwordx4 v[124:127], v4, s[16:19], s34 offen offset:768 sc0 sc1
    s_endpgm
.section .rodata,"a"
.p2align 6
.amdhsa_kernel standalone__kv_cache_quant_int4_int2_kv_with_per_channel_or_per_token_scales__prompt_kernel
  .amdhsa_next_free_vgpr 456
  .amdhsa_next_free_sgpr 102
  .amdhsa_accum_offset 256
  .amdhsa_group_segment_fixed_size 0
  .amdhsa_kernarg_size 80
  .amdhsa_user_sgpr_count 2
  .amdhsa_user_sgpr_kernarg_segment_ptr 1
  .amdhsa_system_sgpr_workgroup_id_x 1
  .amdhsa_float_denorm_mode_32 3
.end_amdhsa_kernel
```
